```python
import torch

def _softmax(x, axis=-1):
    return torch.softmax(x, dim=axis)
def _gelu(x):
    return torch.nn.functional.gelu(x, approximate="tanh")
def _silu(x):
    return torch.nn.functional.silu(x)
def _sigmoid(x):
    return torch.sigmoid(x)
def _layernorm(x, axis=-1, eps=1e-5):
    m = x.mean(dim=axis, keepdim=True)
    v = x.var(dim=axis, keepdim=True, unbiased=False)
    return (x - m) / torch.sqrt(v + eps)
def _scatter_add(tgt, idx, src, axis=0):
    return tgt.clone().index_add_(axis, idx, src)
def _segment_sum(src, seg, n):
    out = torch.zeros((n,) + src.shape[1:], dtype=src.dtype)
    return out.index_add_(0, seg, src)
def _pad(x, pw):
    flat = tuple(v for pair in reversed(pw) for v in pair)
    return torch.nn.functional.pad(x, flat)

kernel_name = 'standalone__qk_norm__prompt'

def setup_inputs():

    _w = (lambda a: (lambda t: t.to(torch.bfloat16) if t.is_floating_point() else t)(torch.as_tensor(a)))
    B, H, S, D = 2, 32, 2048, 576
    Dh = D // H
    return {
        "q": _w((lambda *s: torch.randn(*s, dtype=torch.bfloat16) * 0.05)(B, H, S, Dh)),
        "k": _w((lambda *s: torch.randn(*s, dtype=torch.bfloat16) * 0.05)(B, H, S, Dh)),
        "v": _w((lambda *s: torch.randn(*s, dtype=torch.bfloat16) * 0.4)(B, H, S, Dh)),
        "t": _w(torch.abs((lambda *s: torch.randn(*s, dtype=torch.bfloat16) * 0.4)(H)) + 1.0),
    }

def reference(q, k, v, t):
    eps = 1e-6
    qn = q / (torch.sqrt((q * q).sum(axis=-1, keepdims=True)) + eps)
    kn = k / (torch.sqrt((k * k).sum(axis=-1, keepdims=True)) + eps)
    logits = torch.einsum('bhqd,bhkd->bhqk', qn, kn) * t[None, :, None, None]
    attn = _softmax(logits, axis=-1)
    return torch.einsum('bhqk,bhkd->bhqd', attn, v)
```

```asm
; @launch grid=(256,1,1) block=(512,1,1) lds=86080
.amdgcn_target "amdgcn-amd-amdhsa--gfx950"
.text
.globl standalone__qk_norm__prompt_kernel
.p2align 12
.p2align 8
.type standalone__qk_norm__prompt_kernel,@function
standalone__qk_norm__prompt_kernel:
    s_cmp_ge_u32 s2, 256
    s_cbranch_scc1 L_end
    s_load_dwordx8 s[4:11], s[0:1], 0
    s_load_dwordx2 s[12:13], s[0:1], 32
    v_lshrrev_b32 v16, 6, v0
    s_and_b32 s38, s2, 7
    s_lshr_b32 s39, s2, 3
    v_readfirstlane_b32 s34, v16
    s_and_b32 s33, s39, 3
    s_lshr_b32 s39, s39, 2
    s_lshl_b32 s32, s38, 3
    s_add_u32 s32, s32, s39
    s_mul_i32 s36, s32, 73728
    s_mul_i32 s38, s33, 18432
    s_add_u32 s37, s36, s38
    s_and_b32 s52, s34, 3
    s_mul_i32 s38, s52, 4608
    s_add_u32 s37, s37, s38
    v_and_b32 v1, 63, v0
    v_and_b32 v16, 0xff, v0
    v_mul_u32_u24 v2, 36, v16
    v_mul_u32_u24 v4, 36, v1
    v_and_b32 v16, 0xdf, v0
    v_mul_u32_u24 v3, 36, v16
    v_lshrrev_b32 v17, 5, v1
    v_lshl_add_u32 v3, v17, 4, v3
    s_and_b32 s38, s32, 30
    s_lshl_b32 s38, s38, 1
    s_add_u32 s48, s36, 9216
    s_waitcnt lgkmcnt(0)
    s_load_dword s35, s[10:11], s38
    s_mov_b32 s20, s6
    s_mov_b32 s21, s7
    s_mov_b32 s22, 4718592
    s_mov_b32 s23, 0x00020000
    s_mov_b32 s24, s8
    s_mov_b32 s25, s9
    s_mov_b32 s26, 4718592
    s_mov_b32 s27, 0x00020000
    s_mov_b32 s16, s4
    s_mov_b32 s17, s5
    s_mov_b32 s18, 4718592
    s_mov_b32 s19, 0x00020000
    s_mov_b32 s28, s12
    s_mov_b32 s29, s13
    s_mov_b32 s30, 4718592
    s_mov_b32 s31, 0x00020000
    s_cmp_ge_u32 s34, 4
    s_cbranch_scc1 L_compute
    buffer_load_dwordx4 v[124:127], v3, s[24:27], s36 offen offset:0
    buffer_load_dwordx4 v[128:131], v3, s[24:27], s36 offen offset:1152
    buffer_load_dword v132, v2, s[24:27], s36 offen offset:32
    buffer_load_dwordx4 v[112:115], v2, s[20:23], s36 offen offset:0
    buffer_load_dwordx4 v[116:119], v2, s[20:23], s36 offen offset:16
    buffer_load_dword v120, v2, s[20:23], s36 offen offset:32
    s_branch L_producer
L_compute:
    buffer_load_dwordx4 v[100:103], v4, s[16:19], s37 offen offset:0
    buffer_load_dwordx4 v[104:107], v4, s[16:19], s37 offen offset:16
    buffer_load_dword v108, v4, s[16:19], s37 offen offset:32
    s_mov_b32 s44, 0xffff0000
    s_mov_b32 s45, 0x358637bd
    s_mov_b32 s46, 0x207
    s_mov_b64 s[40:41], 0
    v_mov_b32 v14, 0x15000
    v_lshlrev_b32 v6, 4, v1
    v_add_u32 v7, 0x7000, v6
    v_and_b32 v16, 31, v1
    v_mul_u32_u24 v18, 36, v16
    v_mul_u32_u24 v15, 20, v17
    v_add_u32 v15, v15, v18
    v_lshl_add_u32 v28, v17, 30, v18
    v_mov_b32 v164, 0
    v_mov_b32 v165, 0
    v_mov_b32 v166, 0
    v_mov_b32 v167, 0
    v_mov_b32 v168, 0
    v_mov_b32 v169, 0
    v_mov_b32 v170, 0
    v_mov_b32 v171, 0
    v_mov_b32 v172, 0
    v_mov_b32 v173, 0
    v_mov_b32 v174, 0
    v_mov_b32 v175, 0
    v_mov_b32 v176, 0
    v_mov_b32 v177, 0
    v_mov_b32 v178, 0
    v_mov_b32 v179, 0
    v_mov_b32 v180, 0
    v_mov_b32 v181, 0
    v_mov_b32 v182, 0
    v_mov_b32 v183, 0
    v_mov_b32 v184, 0
    v_mov_b32 v185, 0
    v_mov_b32 v186, 0
    v_mov_b32 v187, 0
    v_mov_b32 v188, 0
    v_mov_b32 v189, 0
    v_mov_b32 v190, 0
    v_mov_b32 v191, 0
    v_mov_b32 v192, 0
    v_mov_b32 v193, 0
    v_mov_b32 v194, 0
    v_mov_b32 v195, 0
    v_mov_b32 v196, 0
    v_mov_b32 v197, 0
    v_mov_b32 v198, 0
    v_mov_b32 v199, 0
    v_mov_b32 v200, 0
    v_mov_b32 v201, 0
    v_mov_b32 v202, 0
    v_mov_b32 v203, 0
    v_mov_b32 v204, 0
    v_mov_b32 v205, 0
    v_mov_b32 v206, 0
    v_mov_b32 v207, 0
    v_mov_b32 v208, 0
    v_mov_b32 v209, 0
    v_mov_b32 v210, 0
    v_mov_b32 v211, 0
    v_mov_b32 v212, 0
    v_mov_b32 v213, 0
    v_mov_b32 v214, 0
    v_mov_b32 v215, 0
    v_mov_b32 v216, 0
    v_mov_b32 v217, 0
    v_mov_b32 v218, 0
    v_mov_b32 v219, 0
    v_mov_b32 v220, 0
    v_mov_b32 v221, 0
    v_mov_b32 v222, 0
    v_mov_b32 v223, 0
    v_mov_b32 v224, 0
    v_mov_b32 v225, 0
    v_mov_b32 v226, 0
    v_mov_b32 v227, 0
    v_mov_b32 v92, 0
    v_mov_b32 v93, 0
    v_mov_b32 v94, 0
    v_mov_b32 v95, 0
    v_mov_b32 v96, 0
    v_mov_b32 v97, 0
    v_mov_b32 v98, 0
    v_mov_b32 v99, 0
    v_mov_b32 v80, 0
    v_mov_b32 v81, 0
    v_mov_b32 v82, 0
    v_mov_b32 v83, 0
    v_mov_b32 v72, 0
    v_mov_b32 v73, 0
    v_mov_b32 v74, 0
    v_mov_b32 v75, 0
    buffer_load_dwordx4 v[148:151], v4, s[16:19], s37 offen offset:2304
    buffer_load_dwordx4 v[152:155], v4, s[16:19], s37 offen offset:2320
    buffer_load_dword v156, v4, s[16:19], s37 offen offset:2336
    s_waitcnt lgkmcnt(0)
    s_lshl_b32 s38, s35, 16
    s_and_b32 s39, s35, 0xffff0000
    s_bitcmp1_b32 s32, 0
    s_cselect_b32 s35, s39, s38
    v_mov_b32 v13, 0x3fb8aa3b
    v_mul_f32 v13, s35, v13
    s_and_b32 s38, s35, 0x7fffffff
    s_cmp_gt_u32 s38, 0x402f0000
    s_cbranch_scc1 L_generic
    s_waitcnt vmcnt(5)
    v_dot2_f32_bf16 v16, v100, v100, 0
    v_dot2_f32_bf16 v17, v101, v101, 0
    v_dot2_f32_bf16 v16, v102, v102, v16
    v_dot2_f32_bf16 v17, v103, v103, v17
    s_waitcnt vmcnt(4)
    v_dot2_f32_bf16 v16, v104, v104, v16
    v_dot2_f32_bf16 v17, v105, v105, v17
    v_dot2_f32_bf16 v16, v106, v106, v16
    v_dot2_f32_bf16 v17, v107, v107, v17
    s_waitcnt vmcnt(3)
    v_dot2_f32_bf16 v16, v108, v108, v16
    v_lshlrev_b32 v20, 16, v100
    v_and_b32 v21, s44, v100
    v_lshlrev_b32 v22, 16, v101
    v_and_b32 v23, s44, v101
    v_add_f32 v16, v16, v17
    v_sqrt_f32 v18, v16
    v_cmp_class_f32 vcc, v16, s46
    v_add_f32 v18, s45, v18
    v_rcp_f32 v18, v18
    v_lshlrev_b32 v24, 16, v102
    v_and_b32 v25, s44, v102
    s_or_b64 s[40:41], s[40:41], vcc
    v_mul_f32 v18, v18, v13
    v_pk_mul_f32 v[20:21], v[20:21], v[18:19] op_sel_hi:[1,0]
    v_lshlrev_b32 v26, 16, v103
    v_and_b32 v27, s44, v103
    v_cvt_pk_f16_f32 v36, v20, v21
    v_pk_mul_f32 v[22:23], v[22:23], v[18:19] op_sel_hi:[1,0]
    v_lshlrev_b32 v20, 16, v104
    v_and_b32 v21, s44, v104
    v_cvt_pk_f16_f32 v37, v22, v23
    v_pk_mul_f32 v[24:25], v[24:25], v[18:19] op_sel_hi:[1,0]
    v_lshlrev_b32 v22, 16, v105
    v_and_b32 v23, s44, v105
    v_cvt_pk_f16_f32 v38, v24, v25
    v_pk_mul_f32 v[26:27], v[26:27], v[18:19] op_sel_hi:[1,0]
    v_lshlrev_b32 v24, 16, v106
    v_and_b32 v25, s44, v106
    v_cvt_pk_f16_f32 v39, v26, v27
    v_pk_mul_f32 v[20:21], v[20:21], v[18:19] op_sel_hi:[1,0]
    v_lshlrev_b32 v26, 16, v107
    v_and_b32 v27, s44, v107
    v_cvt_pk_f16_f32 v40, v20, v21
    v_pk_mul_f32 v[22:23], v[22:23], v[18:19] op_sel_hi:[1,0]
    v_lshlrev_b32 v20, 16, v108
    v_and_b32 v21, s44, v108
    v_cvt_pk_f16_f32 v41, v22, v23
    v_pk_mul_f32 v[24:25], v[24:25], v[18:19] op_sel_hi:[1,0]
    v_cvt_pk_f16_f32 v42, v24, v25
    v_pk_mul_f32 v[26:27], v[26:27], v[18:19] op_sel_hi:[1,0]
    v_cvt_pk_f16_f32 v43, v26, v27
    v_pk_mul_f32 v[20:21], v[20:21], v[18:19] op_sel_hi:[1,0]
    v_cvt_pk_f16_f32 v32, v20, v21
    v_mov_b32 v33, 0x58185a00
    v_permlane32_swap_b32 v36, v40
    v_permlane32_swap_b32 v37, v41
    v_permlane32_swap_b32 v38, v42
    v_permlane32_swap_b32 v39, v43
    s_barrier
    s_mov_b32 s49, 0
    s_mov_b32 s50, 28672
    ds_read_b128 v[60:63], v6 offset:0
    ds_read_b128 v[52:55], v6 offset:2048
    ds_read_b128 v[64:67], v6 offset:1024
    ds_read_b128 v[76:79], v6 offset:4096
    ds_read_b128 v[68:71], v6 offset:3072
    s_waitcnt lgkmcnt(4)
    v_mfma_f32_32x32x16_f16 v[100:115], v[60:63], v[36:39], 0
    v_mfma_f32_32x32x16_f16 v[116:131], v[60:63], v[40:43], 0
    s_waitcnt lgkmcnt(3)
    s_nop 8
    v_mfma_f32_32x32x4_2b_f16 v[100:131], v[52:53], v[32:33], v[100:131]
    s_waitcnt vmcnt(2)
    v_dot2_f32_bf16 v16, v148, v148, 0
    v_dot2_f32_bf16 v17, v149, v149, 0
    v_dot2_f32_bf16 v16, v150, v150, v16
    v_dot2_f32_bf16 v17, v151, v151, v17
    s_waitcnt vmcnt(1)
    v_dot2_f32_bf16 v16, v152, v152, v16
    v_dot2_f32_bf16 v17, v153, v153, v17
    v_dot2_f32_bf16 v16, v154, v154, v16
    v_dot2_f32_bf16 v17, v155, v155, v17
    s_waitcnt vmcnt(0)
    v_dot2_f32_bf16 v16, v156, v156, v16
    v_lshlrev_b32 v20, 16, v148
    v_and_b32 v21, s44, v148
    v_lshlrev_b32 v22, 16, v149
    v_and_b32 v23, s44, v149
    v_add_f32 v16, v16, v17
    v_sqrt_f32 v18, v16
    v_cmp_class_f32 vcc, v16, s46
    v_add_f32 v18, s45, v18
    v_rcp_f32 v18, v18
    v_lshlrev_b32 v24, 16, v150
    v_and_b32 v25, s44, v150
    s_or_b64 s[40:41], s[40:41], vcc
    v_mul_f32 v18, v18, v13
    v_pk_mul_f32 v[20:21], v[20:21], v[18:19] op_sel_hi:[1,0]
    v_lshlrev_b32 v26, 16, v151
    v_and_b32 v27, s44, v151
    v_cvt_pk_f16_f32 v44, v20, v21
    v_pk_mul_f32 v[22:23], v[22:23], v[18:19] op_sel_hi:[1,0]
    v_lshlrev_b32 v20, 16, v152
    v_and_b32 v21, s44, v152
    v_cvt_pk_f16_f32 v45, v22, v23
    v_pk_mul_f32 v[24:25], v[24:25], v[18:19] op_sel_hi:[1,0]
    v_lshlrev_b32 v22, 16, v153
    v_and_b32 v23, s44, v153
    v_cvt_pk_f16_f32 v46, v24, v25
    v_pk_mul_f32 v[26:27], v[26:27], v[18:19] op_sel_hi:[1,0]
    v_lshlrev_b32 v24, 16, v154
    v_and_b32 v25, s44, v154
    v_cvt_pk_f16_f32 v47, v26, v27
    v_pk_mul_f32 v[20:21], v[20:21], v[18:19] op_sel_hi:[1,0]
    v_lshlrev_b32 v26, 16, v155
    v_and_b32 v27, s44, v155
    v_cvt_pk_f16_f32 v48, v20, v21
    v_pk_mul_f32 v[22:23], v[22:23], v[18:19] op_sel_hi:[1,0]
    v_lshlrev_b32 v20, 16, v156
    v_and_b32 v21, s44, v156
    v_cvt_pk_f16_f32 v49, v22, v23
    v_pk_mul_f32 v[24:25], v[24:25], v[18:19] op_sel_hi:[1,0]
    v_cvt_pk_f16_f32 v50, v24, v25
    v_pk_mul_f32 v[26:27], v[26:27], v[18:19] op_sel_hi:[1,0]
    v_cvt_pk_f16_f32 v51, v26, v27
    v_pk_mul_f32 v[20:21], v[20:21], v[18:19] op_sel_hi:[1,0]
    v_cvt_pk_f16_f32 v34, v20, v21
    v_mov_b32 v35, 0x58185a00
    v_permlane32_swap_b32 v44, v48
    v_permlane32_swap_b32 v45, v49
    v_permlane32_swap_b32 v46, v50
    v_permlane32_swap_b32 v47, v51
    s_nop 1
    v_mfma_f32_32x32x16_f16 v[132:147], v[60:63], v[44:47], 0
    v_mfma_f32_32x32x16_f16 v[148:163], v[60:63], v[48:51], 0
    s_waitcnt lgkmcnt(0)
    .p2align 6
L_loop:
    v_exp_f16 v84, v100
    v_exp_f16 v85, v102
    v_exp_f16_sdwa v84, v101 dst_sel:WORD_1 dst_unused:UNUSED_PRESERVE src0_sel:WORD_0
    v_exp_f16_sdwa v85, v103 dst_sel:WORD_1 dst_unused:UNUSED_PRESERVE src0_sel:WORD_0
    v_mfma_f32_32x32x16_f16 v[212:227], v[72:75], v[92:95], v[212:227]
    s_waitcnt lgkmcnt(0)
    ds_read_b128 v[60:63], v6 offset:7168
    ds_read_b128 v[56:59], v6 offset:9216
    v_exp_f16 v86, v104
    v_exp_f16 v87, v106
    v_exp_f16_sdwa v86, v105 dst_sel:WORD_1 dst_unused:UNUSED_PRESERVE src0_sel:WORD_0
    v_exp_f16_sdwa v87, v107 dst_sel:WORD_1 dst_unused:UNUSED_PRESERVE src0_sel:WORD_0
    v_mfma_f32_32x32x16_f16 v[212:227], v[80:83], v[96:99], v[212:227]
    ds_read_b128 v[80:83], v6 offset:6144
    ds_read_b128 v[72:75], v6 offset:5120
    v_exp_f16 v88, v108
    v_exp_f16 v89, v110
    v_exp_f16_sdwa v88, v109 dst_sel:WORD_1 dst_unused:UNUSED_PRESERVE src0_sel:WORD_0
    v_exp_f16_sdwa v89, v111 dst_sel:WORD_1 dst_unused:UNUSED_PRESERVE src0_sel:WORD_0
    v_mfma_f32_32x32x4_2b_f16 v[132:163], v[52:53], v[34:35], v[132:163]
    v_exp_f16 v90, v112
    v_exp_f16 v91, v114
    v_exp_f16_sdwa v90, v113 dst_sel:WORD_1 dst_unused:UNUSED_PRESERVE src0_sel:WORD_0
    v_exp_f16_sdwa v91, v115 dst_sel:WORD_1 dst_unused:UNUSED_PRESERVE src0_sel:WORD_0
    v_exp_f16 v92, v116
    v_exp_f16 v93, v118
    v_exp_f16_sdwa v92, v117 dst_sel:WORD_1 dst_unused:UNUSED_PRESERVE src0_sel:WORD_0
    v_exp_f16_sdwa v93, v119 dst_sel:WORD_1 dst_unused:UNUSED_PRESERVE src0_sel:WORD_0
    v_mfma_f32_32x32x16_f16 v[164:179], v[68:71], v[84:87], v[164:179]
    v_exp_f16 v94, v120
    v_exp_f16 v95, v122
    v_exp_f16_sdwa v94, v121 dst_sel:WORD_1 dst_unused:UNUSED_PRESERVE src0_sel:WORD_0
    v_exp_f16_sdwa v95, v123 dst_sel:WORD_1 dst_unused:UNUSED_PRESERVE src0_sel:WORD_0
    v_mfma_f32_32x32x16_f16 v[164:179], v[76:79], v[88:91], v[164:179]
    v_exp_f16 v96, v124
    v_exp_f16 v97, v126
    v_exp_f16_sdwa v96, v125 dst_sel:WORD_1 dst_unused:UNUSED_PRESERVE src0_sel:WORD_0
    v_exp_f16_sdwa v97, v127 dst_sel:WORD_1 dst_unused:UNUSED_PRESERVE src0_sel:WORD_0
    v_mfma_f32_32x32x16_f16 v[100:115], v[64:67], v[36:39], 0
    v_exp_f16 v98, v128
    v_exp_f16 v99, v130
    v_exp_f16_sdwa v98, v129 dst_sel:WORD_1 dst_unused:UNUSED_PRESERVE src0_sel:WORD_0
    v_exp_f16_sdwa v99, v131 dst_sel:WORD_1 dst_unused:UNUSED_PRESERVE src0_sel:WORD_0
    v_mfma_f32_32x32x16_f16 v[116:131], v[64:67], v[40:43], 0
    v_exp_f16 v84, v132
    v_exp_f16 v85, v134
    v_exp_f16_sdwa v84, v133 dst_sel:WORD_1 dst_unused:UNUSED_PRESERVE src0_sel:WORD_0
    v_exp_f16_sdwa v85, v135 dst_sel:WORD_1 dst_unused:UNUSED_PRESERVE src0_sel:WORD_0
    v_mfma_f32_32x32x16_f16 v[180:195], v[68:71], v[92:95], v[180:195]
    v_exp_f16 v86, v136
    v_exp_f16 v87, v138
    v_exp_f16_sdwa v86, v137 dst_sel:WORD_1 dst_unused:UNUSED_PRESERVE src0_sel:WORD_0
    v_exp_f16_sdwa v87, v139 dst_sel:WORD_1 dst_unused:UNUSED_PRESERVE src0_sel:WORD_0
    v_mfma_f32_32x32x16_f16 v[180:195], v[76:79], v[96:99], v[180:195]
    v_exp_f16 v88, v140
    v_exp_f16 v89, v142
    v_exp_f16_sdwa v88, v141 dst_sel:WORD_1 dst_unused:UNUSED_PRESERVE src0_sel:WORD_0
    v_exp_f16_sdwa v89, v143 dst_sel:WORD_1 dst_unused:UNUSED_PRESERVE src0_sel:WORD_0
    v_mfma_f32_32x32x4_2b_f16 v[100:131], v[54:55], v[32:33], v[100:131]
    v_exp_f16 v90, v144
    v_exp_f16 v91, v146
    v_exp_f16_sdwa v90, v145 dst_sel:WORD_1 dst_unused:UNUSED_PRESERVE src0_sel:WORD_0
    v_exp_f16_sdwa v91, v147 dst_sel:WORD_1 dst_unused:UNUSED_PRESERVE src0_sel:WORD_0
    v_exp_f16 v92, v148
    v_exp_f16 v93, v150
    v_exp_f16_sdwa v92, v149 dst_sel:WORD_1 dst_unused:UNUSED_PRESERVE src0_sel:WORD_0
    v_exp_f16_sdwa v93, v151 dst_sel:WORD_1 dst_unused:UNUSED_PRESERVE src0_sel:WORD_0
    v_mfma_f32_32x32x16_f16 v[196:211], v[68:71], v[84:87], v[196:211]
    v_exp_f16 v94, v152
    v_exp_f16 v95, v154
    v_exp_f16_sdwa v94, v153 dst_sel:WORD_1 dst_unused:UNUSED_PRESERVE src0_sel:WORD_0
    v_exp_f16_sdwa v95, v155 dst_sel:WORD_1 dst_unused:UNUSED_PRESERVE src0_sel:WORD_0
    v_mfma_f32_32x32x16_f16 v[196:211], v[76:79], v[88:91], v[196:211]
    v_exp_f16 v96, v156
    v_exp_f16 v97, v158
    v_exp_f16_sdwa v96, v157 dst_sel:WORD_1 dst_unused:UNUSED_PRESERVE src0_sel:WORD_0
    v_exp_f16_sdwa v97, v159 dst_sel:WORD_1 dst_unused:UNUSED_PRESERVE src0_sel:WORD_0
    v_mfma_f32_32x32x16_f16 v[132:147], v[64:67], v[44:47], 0
    v_exp_f16 v98, v160
    v_exp_f16 v99, v162
    v_exp_f16_sdwa v98, v161 dst_sel:WORD_1 dst_unused:UNUSED_PRESERVE src0_sel:WORD_0
    v_exp_f16_sdwa v99, v163 dst_sel:WORD_1 dst_unused:UNUSED_PRESERVE src0_sel:WORD_0
    v_mfma_f32_32x32x16_f16 v[148:163], v[64:67], v[48:51], 0
    v_exp_f16 v84, v100
    v_exp_f16 v85, v102
    v_exp_f16_sdwa v84, v101 dst_sel:WORD_1 dst_unused:UNUSED_PRESERVE src0_sel:WORD_0
    v_exp_f16_sdwa v85, v103 dst_sel:WORD_1 dst_unused:UNUSED_PRESERVE src0_sel:WORD_0
    v_mfma_f32_32x32x16_f16 v[212:227], v[68:71], v[92:95], v[212:227]
    s_waitcnt lgkmcnt(0)
    ds_read_b128 v[64:67], v6 offset:8192
    v_exp_f16 v86, v104
    v_exp_f16 v87, v106
    v_exp_f16_sdwa v86, v105 dst_sel:WORD_1 dst_unused:UNUSED_PRESERVE src0_sel:WORD_0
    v_exp_f16_sdwa v87, v107 dst_sel:WORD_1 dst_unused:UNUSED_PRESERVE src0_sel:WORD_0
    v_mfma_f32_32x32x16_f16 v[212:227], v[76:79], v[96:99], v[212:227]
    ds_read_b128 v[76:79], v6 offset:11264
    ds_read_b128 v[68:71], v6 offset:10240
    v_exp_f16 v88, v108
    v_exp_f16 v89, v110
    v_exp_f16_sdwa v88, v109 dst_sel:WORD_1 dst_unused:UNUSED_PRESERVE src0_sel:WORD_0
    v_exp_f16_sdwa v89, v111 dst_sel:WORD_1 dst_unused:UNUSED_PRESERVE src0_sel:WORD_0
    v_mfma_f32_32x32x4_2b_f16 v[132:163], v[54:55], v[34:35], v[132:163]
    v_exp_f16 v90, v112
    v_exp_f16 v91, v114
    v_exp_f16_sdwa v90, v113 dst_sel:WORD_1 dst_unused:UNUSED_PRESERVE src0_sel:WORD_0
    v_exp_f16_sdwa v91, v115 dst_sel:WORD_1 dst_unused:UNUSED_PRESERVE src0_sel:WORD_0
    v_exp_f16 v92, v116
    v_exp_f16 v93, v118
    v_exp_f16_sdwa v92, v117 dst_sel:WORD_1 dst_unused:UNUSED_PRESERVE src0_sel:WORD_0
    v_exp_f16_sdwa v93, v119 dst_sel:WORD_1 dst_unused:UNUSED_PRESERVE src0_sel:WORD_0
    v_mfma_f32_32x32x16_f16 v[164:179], v[72:75], v[84:87], v[164:179]
    v_exp_f16 v94, v120
    v_exp_f16 v95, v122
    v_exp_f16_sdwa v94, v121 dst_sel:WORD_1 dst_unused:UNUSED_PRESERVE src0_sel:WORD_0
    v_exp_f16_sdwa v95, v123 dst_sel:WORD_1 dst_unused:UNUSED_PRESERVE src0_sel:WORD_0
    v_mfma_f32_32x32x16_f16 v[164:179], v[80:83], v[88:91], v[164:179]
    v_exp_f16 v96, v124
    v_exp_f16 v97, v126
    v_exp_f16_sdwa v96, v125 dst_sel:WORD_1 dst_unused:UNUSED_PRESERVE src0_sel:WORD_0
    v_exp_f16_sdwa v97, v127 dst_sel:WORD_1 dst_unused:UNUSED_PRESERVE src0_sel:WORD_0
    v_mfma_f32_32x32x16_f16 v[100:115], v[60:63], v[36:39], 0
    v_exp_f16 v98, v128
    v_exp_f16 v99, v130
    v_exp_f16_sdwa v98, v129 dst_sel:WORD_1 dst_unused:UNUSED_PRESERVE src0_sel:WORD_0
    v_exp_f16_sdwa v99, v131 dst_sel:WORD_1 dst_unused:UNUSED_PRESERVE src0_sel:WORD_0
    v_mfma_f32_32x32x16_f16 v[116:131], v[60:63], v[40:43], 0
    v_exp_f16 v84, v132
    v_exp_f16 v85, v134
    v_exp_f16_sdwa v84, v133 dst_sel:WORD_1 dst_unused:UNUSED_PRESERVE src0_sel:WORD_0
    v_exp_f16_sdwa v85, v135 dst_sel:WORD_1 dst_unused:UNUSED_PRESERVE src0_sel:WORD_0
    v_mfma_f32_32x32x16_f16 v[180:195], v[72:75], v[92:95], v[180:195]
    v_exp_f16 v86, v136
    v_exp_f16 v87, v138
    v_exp_f16_sdwa v86, v137 dst_sel:WORD_1 dst_unused:UNUSED_PRESERVE src0_sel:WORD_0
    v_exp_f16_sdwa v87, v139 dst_sel:WORD_1 dst_unused:UNUSED_PRESERVE src0_sel:WORD_0
    v_mfma_f32_32x32x16_f16 v[180:195], v[80:83], v[96:99], v[180:195]
    v_exp_f16 v88, v140
    v_exp_f16 v89, v142
    v_exp_f16_sdwa v88, v141 dst_sel:WORD_1 dst_unused:UNUSED_PRESERVE src0_sel:WORD_0
    v_exp_f16_sdwa v89, v143 dst_sel:WORD_1 dst_unused:UNUSED_PRESERVE src0_sel:WORD_0
    v_mfma_f32_32x32x4_2b_f16 v[100:131], v[56:57], v[32:33], v[100:131]
    v_exp_f16 v90, v144
    v_exp_f16 v91, v146
    v_exp_f16_sdwa v90, v145 dst_sel:WORD_1 dst_unused:UNUSED_PRESERVE src0_sel:WORD_0
    v_exp_f16_sdwa v91, v147 dst_sel:WORD_1 dst_unused:UNUSED_PRESERVE src0_sel:WORD_0
    v_exp_f16 v92, v148
    v_exp_f16 v93, v150
    v_exp_f16_sdwa v92, v149 dst_sel:WORD_1 dst_unused:UNUSED_PRESERVE src0_sel:WORD_0
    v_exp_f16_sdwa v93, v151 dst_sel:WORD_1 dst_unused:UNUSED_PRESERVE src0_sel:WORD_0
    v_mfma_f32_32x32x16_f16 v[196:211], v[72:75], v[84:87], v[196:211]
    v_exp_f16 v94, v152
    v_exp_f16 v95, v154
    v_exp_f16_sdwa v94, v153 dst_sel:WORD_1 dst_unused:UNUSED_PRESERVE src0_sel:WORD_0
    v_exp_f16_sdwa v95, v155 dst_sel:WORD_1 dst_unused:UNUSED_PRESERVE src0_sel:WORD_0
    v_mfma_f32_32x32x16_f16 v[196:211], v[80:83], v[88:91], v[196:211]
    v_exp_f16 v96, v156
    v_exp_f16 v97, v158
    v_exp_f16_sdwa v96, v157 dst_sel:WORD_1 dst_unused:UNUSED_PRESERVE src0_sel:WORD_0
    v_exp_f16_sdwa v97, v159 dst_sel:WORD_1 dst_unused:UNUSED_PRESERVE src0_sel:WORD_0
    v_mfma_f32_32x32x16_f16 v[132:147], v[60:63], v[44:47], 0
    v_exp_f16 v98, v160
    v_exp_f16 v99, v162
    v_exp_f16_sdwa v98, v161 dst_sel:WORD_1 dst_unused:UNUSED_PRESERVE src0_sel:WORD_0
    v_exp_f16_sdwa v99, v163 dst_sel:WORD_1 dst_unused:UNUSED_PRESERVE src0_sel:WORD_0
    v_mfma_f32_32x32x16_f16 v[148:163], v[60:63], v[48:51], 0
    v_exp_f16 v84, v100
    v_exp_f16 v85, v102
    v_exp_f16_sdwa v84, v101 dst_sel:WORD_1 dst_unused:UNUSED_PRESERVE src0_sel:WORD_0
    v_exp_f16_sdwa v85, v103 dst_sel:WORD_1 dst_unused:UNUSED_PRESERVE src0_sel:WORD_0
    v_mfma_f32_32x32x16_f16 v[212:227], v[72:75], v[92:95], v[212:227]
    s_waitcnt lgkmcnt(0)
    ds_read_b128 v[60:63], v6 offset:14336
    ds_read_b128 v[52:55], v6 offset:16384
    v_exp_f16 v86, v104
    v_exp_f16 v87, v106
    v_exp_f16_sdwa v86, v105 dst_sel:WORD_1 dst_unused:UNUSED_PRESERVE src0_sel:WORD_0
    v_exp_f16_sdwa v87, v107 dst_sel:WORD_1 dst_unused:UNUSED_PRESERVE src0_sel:WORD_0
    v_mfma_f32_32x32x16_f16 v[212:227], v[80:83], v[96:99], v[212:227]
    ds_read_b128 v[80:83], v6 offset:13312
    ds_read_b128 v[72:75], v6 offset:12288
    v_exp_f16 v88, v108
    v_exp_f16 v89, v110
    v_exp_f16_sdwa v88, v109 dst_sel:WORD_1 dst_unused:UNUSED_PRESERVE src0_sel:WORD_0
    v_exp_f16_sdwa v89, v111 dst_sel:WORD_1 dst_unused:UNUSED_PRESERVE src0_sel:WORD_0
    v_mfma_f32_32x32x4_2b_f16 v[132:163], v[56:57], v[34:35], v[132:163]
    v_exp_f16 v90, v112
    v_exp_f16 v91, v114
    v_exp_f16_sdwa v90, v113 dst_sel:WORD_1 dst_unused:UNUSED_PRESERVE src0_sel:WORD_0
    v_exp_f16_sdwa v91, v115 dst_sel:WORD_1 dst_unused:UNUSED_PRESERVE src0_sel:WORD_0
    v_exp_f16 v92, v116
    v_exp_f16 v93, v118
    v_exp_f16_sdwa v92, v117 dst_sel:WORD_1 dst_unused:UNUSED_PRESERVE src0_sel:WORD_0
    v_exp_f16_sdwa v93, v119 dst_sel:WORD_1 dst_unused:UNUSED_PRESERVE src0_sel:WORD_0
    v_mfma_f32_32x32x16_f16 v[164:179], v[68:71], v[84:87], v[164:179]
    v_exp_f16 v94, v120
    v_exp_f16 v95, v122
    v_exp_f16_sdwa v94, v121 dst_sel:WORD_1 dst_unused:UNUSED_PRESERVE src0_sel:WORD_0
    v_exp_f16_sdwa v95, v123 dst_sel:WORD_1 dst_unused:UNUSED_PRESERVE src0_sel:WORD_0
    v_mfma_f32_32x32x16_f16 v[164:179], v[76:79], v[88:91], v[164:179]
    v_exp_f16 v96, v124
    v_exp_f16 v97, v126
    v_exp_f16_sdwa v96, v125 dst_sel:WORD_1 dst_unused:UNUSED_PRESERVE src0_sel:WORD_0
    v_exp_f16_sdwa v97, v127 dst_sel:WORD_1 dst_unused:UNUSED_PRESERVE src0_sel:WORD_0
    v_mfma_f32_32x32x16_f16 v[100:115], v[64:67], v[36:39], 0
    v_exp_f16 v98, v128
    v_exp_f16 v99, v130
    v_exp_f16_sdwa v98, v129 dst_sel:WORD_1 dst_unused:UNUSED_PRESERVE src0_sel:WORD_0
    v_exp_f16_sdwa v99, v131 dst_sel:WORD_1 dst_unused:UNUSED_PRESERVE src0_sel:WORD_0
    v_mfma_f32_32x32x16_f16 v[116:131], v[64:67], v[40:43], 0
    v_exp_f16 v84, v132
    v_exp_f16 v85, v134
    v_exp_f16_sdwa v84, v133 dst_sel:WORD_1 dst_unused:UNUSED_PRESERVE src0_sel:WORD_0
    v_exp_f16_sdwa v85, v135 dst_sel:WORD_1 dst_unused:UNUSED_PRESERVE src0_sel:WORD_0
    v_mfma_f32_32x32x16_f16 v[180:195], v[68:71], v[92:95], v[180:195]
    v_exp_f16 v86, v136
    v_exp_f16 v87, v138
    v_exp_f16_sdwa v86, v137 dst_sel:WORD_1 dst_unused:UNUSED_PRESERVE src0_sel:WORD_0
    v_exp_f16_sdwa v87, v139 dst_sel:WORD_1 dst_unused:UNUSED_PRESERVE src0_sel:WORD_0
    v_mfma_f32_32x32x16_f16 v[180:195], v[76:79], v[96:99], v[180:195]
    v_exp_f16 v88, v140
    v_exp_f16 v89, v142
    v_exp_f16_sdwa v88, v141 dst_sel:WORD_1 dst_unused:UNUSED_PRESERVE src0_sel:WORD_0
    v_exp_f16_sdwa v89, v143 dst_sel:WORD_1 dst_unused:UNUSED_PRESERVE src0_sel:WORD_0
    v_mfma_f32_32x32x4_2b_f16 v[100:131], v[58:59], v[32:33], v[100:131]
    v_exp_f16 v90, v144
    v_exp_f16 v91, v146
    v_exp_f16_sdwa v90, v145 dst_sel:WORD_1 dst_unused:UNUSED_PRESERVE src0_sel:WORD_0
    v_exp_f16_sdwa v91, v147 dst_sel:WORD_1 dst_unused:UNUSED_PRESERVE src0_sel:WORD_0
    v_exp_f16 v92, v148
    v_exp_f16 v93, v150
    v_exp_f16_sdwa v92, v149 dst_sel:WORD_1 dst_unused:UNUSED_PRESERVE src0_sel:WORD_0
    v_exp_f16_sdwa v93, v151 dst_sel:WORD_1 dst_unused:UNUSED_PRESERVE src0_sel:WORD_0
    v_mfma_f32_32x32x16_f16 v[196:211], v[68:71], v[84:87], v[196:211]
    v_exp_f16 v94, v152
    v_exp_f16 v95, v154
    v_exp_f16_sdwa v94, v153 dst_sel:WORD_1 dst_unused:UNUSED_PRESERVE src0_sel:WORD_0
    v_exp_f16_sdwa v95, v155 dst_sel:WORD_1 dst_unused:UNUSED_PRESERVE src0_sel:WORD_0
    v_mfma_f32_32x32x16_f16 v[196:211], v[76:79], v[88:91], v[196:211]
    v_exp_f16 v96, v156
    v_exp_f16 v97, v158
    v_exp_f16_sdwa v96, v157 dst_sel:WORD_1 dst_unused:UNUSED_PRESERVE src0_sel:WORD_0
    v_exp_f16_sdwa v97, v159 dst_sel:WORD_1 dst_unused:UNUSED_PRESERVE src0_sel:WORD_0
    v_mfma_f32_32x32x16_f16 v[132:147], v[64:67], v[44:47], 0
    v_exp_f16 v98, v160
    v_exp_f16 v99, v162
    v_exp_f16_sdwa v98, v161 dst_sel:WORD_1 dst_unused:UNUSED_PRESERVE src0_sel:WORD_0
    v_exp_f16_sdwa v99, v163 dst_sel:WORD_1 dst_unused:UNUSED_PRESERVE src0_sel:WORD_0
    v_mfma_f32_32x32x16_f16 v[148:163], v[64:67], v[48:51], 0
    v_exp_f16 v84, v100
    v_exp_f16 v85, v102
    v_exp_f16_sdwa v84, v101 dst_sel:WORD_1 dst_unused:UNUSED_PRESERVE src0_sel:WORD_0
    v_exp_f16_sdwa v85, v103 dst_sel:WORD_1 dst_unused:UNUSED_PRESERVE src0_sel:WORD_0
    v_mfma_f32_32x32x16_f16 v[212:227], v[68:71], v[92:95], v[212:227]
    s_waitcnt lgkmcnt(0)
    ds_read_b128 v[64:67], v6 offset:15360
    v_exp_f16 v86, v104
    v_exp_f16 v87, v106
    v_exp_f16_sdwa v86, v105 dst_sel:WORD_1 dst_unused:UNUSED_PRESERVE src0_sel:WORD_0
    v_exp_f16_sdwa v87, v107 dst_sel:WORD_1 dst_unused:UNUSED_PRESERVE src0_sel:WORD_0
    v_mfma_f32_32x32x16_f16 v[212:227], v[76:79], v[96:99], v[212:227]
    ds_read_b128 v[76:79], v6 offset:18432
    ds_read_b128 v[68:71], v6 offset:17408
    v_exp_f16 v88, v108
    v_exp_f16 v89, v110
    v_exp_f16_sdwa v88, v109 dst_sel:WORD_1 dst_unused:UNUSED_PRESERVE src0_sel:WORD_0
    v_exp_f16_sdwa v89, v111 dst_sel:WORD_1 dst_unused:UNUSED_PRESERVE src0_sel:WORD_0
    v_mfma_f32_32x32x4_2b_f16 v[132:163], v[58:59], v[34:35], v[132:163]
    v_exp_f16 v90, v112
    v_exp_f16 v91, v114
    v_exp_f16_sdwa v90, v113 dst_sel:WORD_1 dst_unused:UNUSED_PRESERVE src0_sel:WORD_0
    v_exp_f16_sdwa v91, v115 dst_sel:WORD_1 dst_unused:UNUSED_PRESERVE src0_sel:WORD_0
    v_exp_f16 v92, v116
    v_exp_f16 v93, v118
    v_exp_f16_sdwa v92, v117 dst_sel:WORD_1 dst_unused:UNUSED_PRESERVE src0_sel:WORD_0
    v_exp_f16_sdwa v93, v119 dst_sel:WORD_1 dst_unused:UNUSED_PRESERVE src0_sel:WORD_0
    v_mfma_f32_32x32x16_f16 v[164:179], v[72:75], v[84:87], v[164:179]
    v_exp_f16 v94, v120
    v_exp_f16 v95, v122
    v_exp_f16_sdwa v94, v121 dst_sel:WORD_1 dst_unused:UNUSED_PRESERVE src0_sel:WORD_0
    v_exp_f16_sdwa v95, v123 dst_sel:WORD_1 dst_unused:UNUSED_PRESERVE src0_sel:WORD_0
    v_mfma_f32_32x32x16_f16 v[164:179], v[80:83], v[88:91], v[164:179]
    v_exp_f16 v96, v124
    v_exp_f16 v97, v126
    v_exp_f16_sdwa v96, v125 dst_sel:WORD_1 dst_unused:UNUSED_PRESERVE src0_sel:WORD_0
    v_exp_f16_sdwa v97, v127 dst_sel:WORD_1 dst_unused:UNUSED_PRESERVE src0_sel:WORD_0
    v_mfma_f32_32x32x16_f16 v[100:115], v[60:63], v[36:39], 0
    v_exp_f16 v98, v128
    v_exp_f16 v99, v130
    v_exp_f16_sdwa v98, v129 dst_sel:WORD_1 dst_unused:UNUSED_PRESERVE src0_sel:WORD_0
    v_exp_f16_sdwa v99, v131 dst_sel:WORD_1 dst_unused:UNUSED_PRESERVE src0_sel:WORD_0
    v_mfma_f32_32x32x16_f16 v[116:131], v[60:63], v[40:43], 0
    v_exp_f16 v84, v132
    v_exp_f16 v85, v134
    v_exp_f16_sdwa v84, v133 dst_sel:WORD_1 dst_unused:UNUSED_PRESERVE src0_sel:WORD_0
    v_exp_f16_sdwa v85, v135 dst_sel:WORD_1 dst_unused:UNUSED_PRESERVE src0_sel:WORD_0
    v_mfma_f32_32x32x16_f16 v[180:195], v[72:75], v[92:95], v[180:195]
    v_exp_f16 v86, v136
    v_exp_f16 v87, v138
    v_exp_f16_sdwa v86, v137 dst_sel:WORD_1 dst_unused:UNUSED_PRESERVE src0_sel:WORD_0
    v_exp_f16_sdwa v87, v139 dst_sel:WORD_1 dst_unused:UNUSED_PRESERVE src0_sel:WORD_0
    v_mfma_f32_32x32x16_f16 v[180:195], v[80:83], v[96:99], v[180:195]
    v_exp_f16 v88, v140
    v_exp_f16 v89, v142
    v_exp_f16_sdwa v88, v141 dst_sel:WORD_1 dst_unused:UNUSED_PRESERVE src0_sel:WORD_0
    v_exp_f16_sdwa v89, v143 dst_sel:WORD_1 dst_unused:UNUSED_PRESERVE src0_sel:WORD_0
    v_mfma_f32_32x32x4_2b_f16 v[100:131], v[52:53], v[32:33], v[100:131]
    v_exp_f16 v90, v144
    v_exp_f16 v91, v146
    v_exp_f16_sdwa v90, v145 dst_sel:WORD_1 dst_unused:UNUSED_PRESERVE src0_sel:WORD_0
    v_exp_f16_sdwa v91, v147 dst_sel:WORD_1 dst_unused:UNUSED_PRESERVE src0_sel:WORD_0
    v_exp_f16 v92, v148
    v_exp_f16 v93, v150
    v_exp_f16_sdwa v92, v149 dst_sel:WORD_1 dst_unused:UNUSED_PRESERVE src0_sel:WORD_0
    v_exp_f16_sdwa v93, v151 dst_sel:WORD_1 dst_unused:UNUSED_PRESERVE src0_sel:WORD_0
    v_mfma_f32_32x32x16_f16 v[196:211], v[72:75], v[84:87], v[196:211]
    v_exp_f16 v94, v152
    v_exp_f16 v95, v154
    v_exp_f16_sdwa v94, v153 dst_sel:WORD_1 dst_unused:UNUSED_PRESERVE src0_sel:WORD_0
    v_exp_f16_sdwa v95, v155 dst_sel:WORD_1 dst_unused:UNUSED_PRESERVE src0_sel:WORD_0
    v_mfma_f32_32x32x16_f16 v[196:211], v[80:83], v[88:91], v[196:211]
    v_exp_f16 v96, v156
    v_exp_f16 v97, v158
    v_exp_f16_sdwa v96, v157 dst_sel:WORD_1 dst_unused:UNUSED_PRESERVE src0_sel:WORD_0
    v_exp_f16_sdwa v97, v159 dst_sel:WORD_1 dst_unused:UNUSED_PRESERVE src0_sel:WORD_0
    v_mfma_f32_32x32x16_f16 v[132:147], v[60:63], v[44:47], 0
    v_exp_f16 v98, v160
    v_exp_f16 v99, v162
    v_exp_f16_sdwa v98, v161 dst_sel:WORD_1 dst_unused:UNUSED_PRESERVE src0_sel:WORD_0
    v_exp_f16_sdwa v99, v163 dst_sel:WORD_1 dst_unused:UNUSED_PRESERVE src0_sel:WORD_0
    v_mfma_f32_32x32x16_f16 v[148:163], v[60:63], v[48:51], 0
    v_exp_f16 v84, v100
    v_exp_f16 v85, v102
    v_exp_f16_sdwa v84, v101 dst_sel:WORD_1 dst_unused:UNUSED_PRESERVE src0_sel:WORD_0
    v_exp_f16_sdwa v85, v103 dst_sel:WORD_1 dst_unused:UNUSED_PRESERVE src0_sel:WORD_0
    v_mfma_f32_32x32x16_f16 v[212:227], v[72:75], v[92:95], v[212:227]
    s_waitcnt lgkmcnt(0)
    ds_read_b128 v[60:63], v6 offset:21504
    ds_read_b128 v[56:59], v6 offset:23552
    v_exp_f16 v86, v104
    v_exp_f16 v87, v106
    v_exp_f16_sdwa v86, v105 dst_sel:WORD_1 dst_unused:UNUSED_PRESERVE src0_sel:WORD_0
    v_exp_f16_sdwa v87, v107 dst_sel:WORD_1 dst_unused:UNUSED_PRESERVE src0_sel:WORD_0
    v_mfma_f32_32x32x16_f16 v[212:227], v[80:83], v[96:99], v[212:227]
    ds_read_b128 v[80:83], v6 offset:20480
    ds_read_b128 v[72:75], v6 offset:19456
    v_exp_f16 v88, v108
    v_exp_f16 v89, v110
    v_exp_f16_sdwa v88, v109 dst_sel:WORD_1 dst_unused:UNUSED_PRESERVE src0_sel:WORD_0
    v_exp_f16_sdwa v89, v111 dst_sel:WORD_1 dst_unused:UNUSED_PRESERVE src0_sel:WORD_0
    v_mfma_f32_32x32x4_2b_f16 v[132:163], v[52:53], v[34:35], v[132:163]
    v_exp_f16 v90, v112
    v_exp_f16 v91, v114
    v_exp_f16_sdwa v90, v113 dst_sel:WORD_1 dst_unused:UNUSED_PRESERVE src0_sel:WORD_0
    v_exp_f16_sdwa v91, v115 dst_sel:WORD_1 dst_unused:UNUSED_PRESERVE src0_sel:WORD_0
    v_exp_f16 v92, v116
    v_exp_f16 v93, v118
    v_exp_f16_sdwa v92, v117 dst_sel:WORD_1 dst_unused:UNUSED_PRESERVE src0_sel:WORD_0
    v_exp_f16_sdwa v93, v119 dst_sel:WORD_1 dst_unused:UNUSED_PRESERVE src0_sel:WORD_0
    v_mfma_f32_32x32x16_f16 v[164:179], v[68:71], v[84:87], v[164:179]
    v_exp_f16 v94, v120
    v_exp_f16 v95, v122
    v_exp_f16_sdwa v94, v121 dst_sel:WORD_1 dst_unused:UNUSED_PRESERVE src0_sel:WORD_0
    v_exp_f16_sdwa v95, v123 dst_sel:WORD_1 dst_unused:UNUSED_PRESERVE src0_sel:WORD_0
    v_mfma_f32_32x32x16_f16 v[164:179], v[76:79], v[88:91], v[164:179]
    v_exp_f16 v96, v124
    v_exp_f16 v97, v126
    v_exp_f16_sdwa v96, v125 dst_sel:WORD_1 dst_unused:UNUSED_PRESERVE src0_sel:WORD_0
    v_exp_f16_sdwa v97, v127 dst_sel:WORD_1 dst_unused:UNUSED_PRESERVE src0_sel:WORD_0
    v_mfma_f32_32x32x16_f16 v[100:115], v[64:67], v[36:39], 0
    v_exp_f16 v98, v128
    v_exp_f16 v99, v130
    v_exp_f16_sdwa v98, v129 dst_sel:WORD_1 dst_unused:UNUSED_PRESERVE src0_sel:WORD_0
    v_exp_f16_sdwa v99, v131 dst_sel:WORD_1 dst_unused:UNUSED_PRESERVE src0_sel:WORD_0
    v_mfma_f32_32x32x16_f16 v[116:131], v[64:67], v[40:43], 0
    v_exp_f16 v84, v132
    v_exp_f16 v85, v134
    v_exp_f16_sdwa v84, v133 dst_sel:WORD_1 dst_unused:UNUSED_PRESERVE src0_sel:WORD_0
    v_exp_f16_sdwa v85, v135 dst_sel:WORD_1 dst_unused:UNUSED_PRESERVE src0_sel:WORD_0
    v_mfma_f32_32x32x16_f16 v[180:195], v[68:71], v[92:95], v[180:195]
    v_exp_f16 v86, v136
    v_exp_f16 v87, v138
    v_exp_f16_sdwa v86, v137 dst_sel:WORD_1 dst_unused:UNUSED_PRESERVE src0_sel:WORD_0
    v_exp_f16_sdwa v87, v139 dst_sel:WORD_1 dst_unused:UNUSED_PRESERVE src0_sel:WORD_0
    v_mfma_f32_32x32x16_f16 v[180:195], v[76:79], v[96:99], v[180:195]
    v_exp_f16 v88, v140
    v_exp_f16 v89, v142
    v_exp_f16_sdwa v88, v141 dst_sel:WORD_1 dst_unused:UNUSED_PRESERVE src0_sel:WORD_0
    v_exp_f16_sdwa v89, v143 dst_sel:WORD_1 dst_unused:UNUSED_PRESERVE src0_sel:WORD_0
    v_mfma_f32_32x32x4_2b_f16 v[100:131], v[54:55], v[32:33], v[100:131]
    v_exp_f16 v90, v144
    v_exp_f16 v91, v146
    v_exp_f16_sdwa v90, v145 dst_sel:WORD_1 dst_unused:UNUSED_PRESERVE src0_sel:WORD_0
    v_exp_f16_sdwa v91, v147 dst_sel:WORD_1 dst_unused:UNUSED_PRESERVE src0_sel:WORD_0
    v_exp_f16 v92, v148
    v_exp_f16 v93, v150
    v_exp_f16_sdwa v92, v149 dst_sel:WORD_1 dst_unused:UNUSED_PRESERVE src0_sel:WORD_0
    v_exp_f16_sdwa v93, v151 dst_sel:WORD_1 dst_unused:UNUSED_PRESERVE src0_sel:WORD_0
    v_mfma_f32_32x32x16_f16 v[196:211], v[68:71], v[84:87], v[196:211]
    v_exp_f16 v94, v152
    v_exp_f16 v95, v154
    v_exp_f16_sdwa v94, v153 dst_sel:WORD_1 dst_unused:UNUSED_PRESERVE src0_sel:WORD_0
    v_exp_f16_sdwa v95, v155 dst_sel:WORD_1 dst_unused:UNUSED_PRESERVE src0_sel:WORD_0
    v_mfma_f32_32x32x16_f16 v[196:211], v[76:79], v[88:91], v[196:211]
    v_exp_f16 v96, v156
    v_exp_f16 v97, v158
    v_exp_f16_sdwa v96, v157 dst_sel:WORD_1 dst_unused:UNUSED_PRESERVE src0_sel:WORD_0
    v_exp_f16_sdwa v97, v159 dst_sel:WORD_1 dst_unused:UNUSED_PRESERVE src0_sel:WORD_0
    v_mfma_f32_32x32x16_f16 v[132:147], v[64:67], v[44:47], 0
    v_exp_f16 v98, v160
    v_exp_f16 v99, v162
    v_exp_f16_sdwa v98, v161 dst_sel:WORD_1 dst_unused:UNUSED_PRESERVE src0_sel:WORD_0
    v_exp_f16_sdwa v99, v163 dst_sel:WORD_1 dst_unused:UNUSED_PRESERVE src0_sel:WORD_0
    v_mfma_f32_32x32x16_f16 v[148:163], v[64:67], v[48:51], 0
    s_barrier
    v_exp_f16 v84, v100
    v_exp_f16 v85, v102
    v_exp_f16_sdwa v84, v101 dst_sel:WORD_1 dst_unused:UNUSED_PRESERVE src0_sel:WORD_0
    v_exp_f16_sdwa v85, v103 dst_sel:WORD_1 dst_unused:UNUSED_PRESERVE src0_sel:WORD_0
    v_mfma_f32_32x32x16_f16 v[212:227], v[68:71], v[92:95], v[212:227]
    s_waitcnt lgkmcnt(0)
    ds_read_b128 v[64:67], v6 offset:22528
    v_exp_f16 v86, v104
    v_exp_f16 v87, v106
    v_exp_f16_sdwa v86, v105 dst_sel:WORD_1 dst_unused:UNUSED_PRESERVE src0_sel:WORD_0
    v_exp_f16_sdwa v87, v107 dst_sel:WORD_1 dst_unused:UNUSED_PRESERVE src0_sel:WORD_0
    v_mfma_f32_32x32x16_f16 v[212:227], v[76:79], v[96:99], v[212:227]
    ds_read_b128 v[76:79], v6 offset:25600
    ds_read_b128 v[68:71], v6 offset:24576
    v_exp_f16 v88, v108
    v_exp_f16 v89, v110
    v_exp_f16_sdwa v88, v109 dst_sel:WORD_1 dst_unused:UNUSED_PRESERVE src0_sel:WORD_0
    v_exp_f16_sdwa v89, v111 dst_sel:WORD_1 dst_unused:UNUSED_PRESERVE src0_sel:WORD_0
    v_mfma_f32_32x32x4_2b_f16 v[132:163], v[54:55], v[34:35], v[132:163]
    v_exp_f16 v90, v112
    v_exp_f16 v91, v114
    v_exp_f16_sdwa v90, v113 dst_sel:WORD_1 dst_unused:UNUSED_PRESERVE src0_sel:WORD_0
    v_exp_f16_sdwa v91, v115 dst_sel:WORD_1 dst_unused:UNUSED_PRESERVE src0_sel:WORD_0
    v_exp_f16 v92, v116
    v_exp_f16 v93, v118
    v_exp_f16_sdwa v92, v117 dst_sel:WORD_1 dst_unused:UNUSED_PRESERVE src0_sel:WORD_0
    v_exp_f16_sdwa v93, v119 dst_sel:WORD_1 dst_unused:UNUSED_PRESERVE src0_sel:WORD_0
    v_mfma_f32_32x32x16_f16 v[164:179], v[72:75], v[84:87], v[164:179]
    v_exp_f16 v94, v120
    v_exp_f16 v95, v122
    v_exp_f16_sdwa v94, v121 dst_sel:WORD_1 dst_unused:UNUSED_PRESERVE src0_sel:WORD_0
    v_exp_f16_sdwa v95, v123 dst_sel:WORD_1 dst_unused:UNUSED_PRESERVE src0_sel:WORD_0
    v_mfma_f32_32x32x16_f16 v[164:179], v[80:83], v[88:91], v[164:179]
    v_exp_f16 v96, v124
    v_exp_f16 v97, v126
    v_exp_f16_sdwa v96, v125 dst_sel:WORD_1 dst_unused:UNUSED_PRESERVE src0_sel:WORD_0
    v_exp_f16_sdwa v97, v127 dst_sel:WORD_1 dst_unused:UNUSED_PRESERVE src0_sel:WORD_0
    v_mfma_f32_32x32x16_f16 v[100:115], v[60:63], v[36:39], 0
    v_exp_f16 v98, v128
    v_exp_f16 v99, v130
    v_exp_f16_sdwa v98, v129 dst_sel:WORD_1 dst_unused:UNUSED_PRESERVE src0_sel:WORD_0
    v_exp_f16_sdwa v99, v131 dst_sel:WORD_1 dst_unused:UNUSED_PRESERVE src0_sel:WORD_0
    v_mfma_f32_32x32x16_f16 v[116:131], v[60:63], v[40:43], 0
    v_exp_f16 v84, v132
    v_exp_f16 v85, v134
    v_exp_f16_sdwa v84, v133 dst_sel:WORD_1 dst_unused:UNUSED_PRESERVE src0_sel:WORD_0
    v_exp_f16_sdwa v85, v135 dst_sel:WORD_1 dst_unused:UNUSED_PRESERVE src0_sel:WORD_0
    v_mfma_f32_32x32x16_f16 v[180:195], v[72:75], v[92:95], v[180:195]
    v_exp_f16 v86, v136
    v_exp_f16 v87, v138
    v_exp_f16_sdwa v86, v137 dst_sel:WORD_1 dst_unused:UNUSED_PRESERVE src0_sel:WORD_0
    v_exp_f16_sdwa v87, v139 dst_sel:WORD_1 dst_unused:UNUSED_PRESERVE src0_sel:WORD_0
    v_mfma_f32_32x32x16_f16 v[180:195], v[80:83], v[96:99], v[180:195]
    v_exp_f16 v88, v140
    v_exp_f16 v89, v142
    v_exp_f16_sdwa v88, v141 dst_sel:WORD_1 dst_unused:UNUSED_PRESERVE src0_sel:WORD_0
    v_exp_f16_sdwa v89, v143 dst_sel:WORD_1 dst_unused:UNUSED_PRESERVE src0_sel:WORD_0
    v_mfma_f32_32x32x4_2b_f16 v[100:131], v[56:57], v[32:33], v[100:131]
    v_exp_f16 v90, v144
    v_exp_f16 v91, v146
    v_exp_f16_sdwa v90, v145 dst_sel:WORD_1 dst_unused:UNUSED_PRESERVE src0_sel:WORD_0
    v_exp_f16_sdwa v91, v147 dst_sel:WORD_1 dst_unused:UNUSED_PRESERVE src0_sel:WORD_0
    v_exp_f16 v92, v148
    v_exp_f16 v93, v150
    v_exp_f16_sdwa v92, v149 dst_sel:WORD_1 dst_unused:UNUSED_PRESERVE src0_sel:WORD_0
    v_exp_f16_sdwa v93, v151 dst_sel:WORD_1 dst_unused:UNUSED_PRESERVE src0_sel:WORD_0
    v_mfma_f32_32x32x16_f16 v[196:211], v[72:75], v[84:87], v[196:211]
    v_exp_f16 v94, v152
    v_exp_f16 v95, v154
    v_exp_f16_sdwa v94, v153 dst_sel:WORD_1 dst_unused:UNUSED_PRESERVE src0_sel:WORD_0
    v_exp_f16_sdwa v95, v155 dst_sel:WORD_1 dst_unused:UNUSED_PRESERVE src0_sel:WORD_0
    v_mfma_f32_32x32x16_f16 v[196:211], v[80:83], v[88:91], v[196:211]
    v_exp_f16 v96, v156
    v_exp_f16 v97, v158
    v_exp_f16_sdwa v96, v157 dst_sel:WORD_1 dst_unused:UNUSED_PRESERVE src0_sel:WORD_0
    v_exp_f16_sdwa v97, v159 dst_sel:WORD_1 dst_unused:UNUSED_PRESERVE src0_sel:WORD_0
    v_mfma_f32_32x32x16_f16 v[132:147], v[60:63], v[44:47], 0
    v_exp_f16 v98, v160
    v_exp_f16 v99, v162
    v_exp_f16_sdwa v98, v161 dst_sel:WORD_1 dst_unused:UNUSED_PRESERVE src0_sel:WORD_0
    v_exp_f16_sdwa v99, v163 dst_sel:WORD_1 dst_unused:UNUSED_PRESERVE src0_sel:WORD_0
    v_mfma_f32_32x32x16_f16 v[148:163], v[60:63], v[48:51], 0
    v_exp_f16 v84, v100
    v_exp_f16 v85, v102
    v_exp_f16_sdwa v84, v101 dst_sel:WORD_1 dst_unused:UNUSED_PRESERVE src0_sel:WORD_0
    v_exp_f16_sdwa v85, v103 dst_sel:WORD_1 dst_unused:UNUSED_PRESERVE src0_sel:WORD_0
    v_mfma_f32_32x32x16_f16 v[212:227], v[72:75], v[92:95], v[212:227]
    s_waitcnt lgkmcnt(0)
    ds_read_b128 v[60:63], v7 offset:0
    ds_read_b128 v[52:55], v7 offset:2048
    v_exp_f16 v86, v104
    v_exp_f16 v87, v106
    v_exp_f16_sdwa v86, v105 dst_sel:WORD_1 dst_unused:UNUSED_PRESERVE src0_sel:WORD_0
    v_exp_f16_sdwa v87, v107 dst_sel:WORD_1 dst_unused:UNUSED_PRESERVE src0_sel:WORD_0
    v_mfma_f32_32x32x16_f16 v[212:227], v[80:83], v[96:99], v[212:227]
    ds_read_b128 v[80:83], v6 offset:27648
    ds_read_b128 v[72:75], v6 offset:26624
    v_exp_f16 v88, v108
    v_exp_f16 v89, v110
    v_exp_f16_sdwa v88, v109 dst_sel:WORD_1 dst_unused:UNUSED_PRESERVE src0_sel:WORD_0
    v_exp_f16_sdwa v89, v111 dst_sel:WORD_1 dst_unused:UNUSED_PRESERVE src0_sel:WORD_0
    v_mfma_f32_32x32x4_2b_f16 v[132:163], v[56:57], v[34:35], v[132:163]
    v_exp_f16 v90, v112
    v_exp_f16 v91, v114
    v_exp_f16_sdwa v90, v113 dst_sel:WORD_1 dst_unused:UNUSED_PRESERVE src0_sel:WORD_0
    v_exp_f16_sdwa v91, v115 dst_sel:WORD_1 dst_unused:UNUSED_PRESERVE src0_sel:WORD_0
    v_exp_f16 v92, v116
    v_exp_f16 v93, v118
    v_exp_f16_sdwa v92, v117 dst_sel:WORD_1 dst_unused:UNUSED_PRESERVE src0_sel:WORD_0
    v_exp_f16_sdwa v93, v119 dst_sel:WORD_1 dst_unused:UNUSED_PRESERVE src0_sel:WORD_0
    v_mfma_f32_32x32x16_f16 v[164:179], v[68:71], v[84:87], v[164:179]
    v_exp_f16 v94, v120
    v_exp_f16 v95, v122
    v_exp_f16_sdwa v94, v121 dst_sel:WORD_1 dst_unused:UNUSED_PRESERVE src0_sel:WORD_0
    v_exp_f16_sdwa v95, v123 dst_sel:WORD_1 dst_unused:UNUSED_PRESERVE src0_sel:WORD_0
    v_mfma_f32_32x32x16_f16 v[164:179], v[76:79], v[88:91], v[164:179]
    v_exp_f16 v96, v124
    v_exp_f16 v97, v126
    v_exp_f16_sdwa v96, v125 dst_sel:WORD_1 dst_unused:UNUSED_PRESERVE src0_sel:WORD_0
    v_exp_f16_sdwa v97, v127 dst_sel:WORD_1 dst_unused:UNUSED_PRESERVE src0_sel:WORD_0
    v_mfma_f32_32x32x16_f16 v[100:115], v[64:67], v[36:39], 0
    v_exp_f16 v98, v128
    v_exp_f16 v99, v130
    v_exp_f16_sdwa v98, v129 dst_sel:WORD_1 dst_unused:UNUSED_PRESERVE src0_sel:WORD_0
    v_exp_f16_sdwa v99, v131 dst_sel:WORD_1 dst_unused:UNUSED_PRESERVE src0_sel:WORD_0
    v_mfma_f32_32x32x16_f16 v[116:131], v[64:67], v[40:43], 0
    v_exp_f16 v84, v132
    v_exp_f16 v85, v134
    v_exp_f16_sdwa v84, v133 dst_sel:WORD_1 dst_unused:UNUSED_PRESERVE src0_sel:WORD_0
    v_exp_f16_sdwa v85, v135 dst_sel:WORD_1 dst_unused:UNUSED_PRESERVE src0_sel:WORD_0
    v_mfma_f32_32x32x16_f16 v[180:195], v[68:71], v[92:95], v[180:195]
    v_exp_f16 v86, v136
    v_exp_f16 v87, v138
    v_exp_f16_sdwa v86, v137 dst_sel:WORD_1 dst_unused:UNUSED_PRESERVE src0_sel:WORD_0
    v_exp_f16_sdwa v87, v139 dst_sel:WORD_1 dst_unused:UNUSED_PRESERVE src0_sel:WORD_0
    v_mfma_f32_32x32x16_f16 v[180:195], v[76:79], v[96:99], v[180:195]
    v_exp_f16 v88, v140
    v_exp_f16 v89, v142
    v_exp_f16_sdwa v88, v141 dst_sel:WORD_1 dst_unused:UNUSED_PRESERVE src0_sel:WORD_0
    v_exp_f16_sdwa v89, v143 dst_sel:WORD_1 dst_unused:UNUSED_PRESERVE src0_sel:WORD_0
    v_mfma_f32_32x32x4_2b_f16 v[100:131], v[58:59], v[32:33], v[100:131]
    v_exp_f16 v90, v144
    v_exp_f16 v91, v146
    v_exp_f16_sdwa v90, v145 dst_sel:WORD_1 dst_unused:UNUSED_PRESERVE src0_sel:WORD_0
    v_exp_f16_sdwa v91, v147 dst_sel:WORD_1 dst_unused:UNUSED_PRESERVE src0_sel:WORD_0
    v_exp_f16 v92, v148
    v_exp_f16 v93, v150
    v_exp_f16_sdwa v92, v149 dst_sel:WORD_1 dst_unused:UNUSED_PRESERVE src0_sel:WORD_0
    v_exp_f16_sdwa v93, v151 dst_sel:WORD_1 dst_unused:UNUSED_PRESERVE src0_sel:WORD_0
    v_mfma_f32_32x32x16_f16 v[196:211], v[68:71], v[84:87], v[196:211]
    v_exp_f16 v94, v152
    v_exp_f16 v95, v154
    v_exp_f16_sdwa v94, v153 dst_sel:WORD_1 dst_unused:UNUSED_PRESERVE src0_sel:WORD_0
    v_exp_f16_sdwa v95, v155 dst_sel:WORD_1 dst_unused:UNUSED_PRESERVE src0_sel:WORD_0
    v_mfma_f32_32x32x16_f16 v[196:211], v[76:79], v[88:91], v[196:211]
    v_exp_f16 v96, v156
    v_exp_f16 v97, v158
    v_exp_f16_sdwa v96, v157 dst_sel:WORD_1 dst_unused:UNUSED_PRESERVE src0_sel:WORD_0
    v_exp_f16_sdwa v97, v159 dst_sel:WORD_1 dst_unused:UNUSED_PRESERVE src0_sel:WORD_0
    v_mfma_f32_32x32x16_f16 v[132:147], v[64:67], v[44:47], 0
    v_exp_f16 v98, v160
    v_exp_f16 v99, v162
    v_exp_f16_sdwa v98, v161 dst_sel:WORD_1 dst_unused:UNUSED_PRESERVE src0_sel:WORD_0
    v_exp_f16_sdwa v99, v163 dst_sel:WORD_1 dst_unused:UNUSED_PRESERVE src0_sel:WORD_0
    v_mfma_f32_32x32x16_f16 v[148:163], v[64:67], v[48:51], 0
    v_exp_f16 v84, v100
    v_exp_f16 v85, v102
    v_exp_f16_sdwa v84, v101 dst_sel:WORD_1 dst_unused:UNUSED_PRESERVE src0_sel:WORD_0
    v_exp_f16_sdwa v85, v103 dst_sel:WORD_1 dst_unused:UNUSED_PRESERVE src0_sel:WORD_0
    v_mfma_f32_32x32x16_f16 v[212:227], v[68:71], v[92:95], v[212:227]
    s_waitcnt lgkmcnt(0)
    ds_read_b128 v[64:67], v7 offset:1024
    v_exp_f16 v86, v104
    v_exp_f16 v87, v106
    v_exp_f16_sdwa v86, v105 dst_sel:WORD_1 dst_unused:UNUSED_PRESERVE src0_sel:WORD_0
    v_exp_f16_sdwa v87, v107 dst_sel:WORD_1 dst_unused:UNUSED_PRESERVE src0_sel:WORD_0
    v_mfma_f32_32x32x16_f16 v[212:227], v[76:79], v[96:99], v[212:227]
    ds_read_b128 v[76:79], v7 offset:4096
    ds_read_b128 v[68:71], v7 offset:3072
    v_exp_f16 v88, v108
    v_exp_f16 v89, v110
    v_exp_f16_sdwa v88, v109 dst_sel:WORD_1 dst_unused:UNUSED_PRESERVE src0_sel:WORD_0
    v_exp_f16_sdwa v89, v111 dst_sel:WORD_1 dst_unused:UNUSED_PRESERVE src0_sel:WORD_0
    v_mfma_f32_32x32x4_2b_f16 v[132:163], v[58:59], v[34:35], v[132:163]
    v_exp_f16 v90, v112
    v_exp_f16 v91, v114
    v_exp_f16_sdwa v90, v113 dst_sel:WORD_1 dst_unused:UNUSED_PRESERVE src0_sel:WORD_0
    v_exp_f16_sdwa v91, v115 dst_sel:WORD_1 dst_unused:UNUSED_PRESERVE src0_sel:WORD_0
    v_exp_f16 v92, v116
    v_exp_f16 v93, v118
    v_exp_f16_sdwa v92, v117 dst_sel:WORD_1 dst_unused:UNUSED_PRESERVE src0_sel:WORD_0
    v_exp_f16_sdwa v93, v119 dst_sel:WORD_1 dst_unused:UNUSED_PRESERVE src0_sel:WORD_0
    v_mfma_f32_32x32x16_f16 v[164:179], v[72:75], v[84:87], v[164:179]
    v_exp_f16 v94, v120
    v_exp_f16 v95, v122
    v_exp_f16_sdwa v94, v121 dst_sel:WORD_1 dst_unused:UNUSED_PRESERVE src0_sel:WORD_0
    v_exp_f16_sdwa v95, v123 dst_sel:WORD_1 dst_unused:UNUSED_PRESERVE src0_sel:WORD_0
    v_mfma_f32_32x32x16_f16 v[164:179], v[80:83], v[88:91], v[164:179]
    v_exp_f16 v96, v124
    v_exp_f16 v97, v126
    v_exp_f16_sdwa v96, v125 dst_sel:WORD_1 dst_unused:UNUSED_PRESERVE src0_sel:WORD_0
    v_exp_f16_sdwa v97, v127 dst_sel:WORD_1 dst_unused:UNUSED_PRESERVE src0_sel:WORD_0
    v_mfma_f32_32x32x16_f16 v[100:115], v[60:63], v[36:39], 0
    v_exp_f16 v98, v128
    v_exp_f16 v99, v130
    v_exp_f16_sdwa v98, v129 dst_sel:WORD_1 dst_unused:UNUSED_PRESERVE src0_sel:WORD_0
    v_exp_f16_sdwa v99, v131 dst_sel:WORD_1 dst_unused:UNUSED_PRESERVE src0_sel:WORD_0
    v_mfma_f32_32x32x16_f16 v[116:131], v[60:63], v[40:43], 0
    v_exp_f16 v84, v132
    v_exp_f16 v85, v134
    v_exp_f16_sdwa v84, v133 dst_sel:WORD_1 dst_unused:UNUSED_PRESERVE src0_sel:WORD_0
    v_exp_f16_sdwa v85, v135 dst_sel:WORD_1 dst_unused:UNUSED_PRESERVE src0_sel:WORD_0
    v_mfma_f32_32x32x16_f16 v[180:195], v[72:75], v[92:95], v[180:195]
    s_add_u32 s50, s50, 28672
    v_exp_f16 v86, v136
    v_exp_f16 v87, v138
    v_exp_f16_sdwa v86, v137 dst_sel:WORD_1 dst_unused:UNUSED_PRESERVE src0_sel:WORD_0
    v_exp_f16_sdwa v87, v139 dst_sel:WORD_1 dst_unused:UNUSED_PRESERVE src0_sel:WORD_0
    v_mfma_f32_32x32x16_f16 v[180:195], v[80:83], v[96:99], v[180:195]
    s_cmp_ge_u32 s50, 86016
    v_exp_f16 v88, v140
    v_exp_f16 v89, v142
    v_exp_f16_sdwa v88, v141 dst_sel:WORD_1 dst_unused:UNUSED_PRESERVE src0_sel:WORD_0
    v_exp_f16_sdwa v89, v143 dst_sel:WORD_1 dst_unused:UNUSED_PRESERVE src0_sel:WORD_0
    v_mfma_f32_32x32x4_2b_f16 v[100:131], v[52:53], v[32:33], v[100:131]
    v_exp_f16 v90, v144
    v_exp_f16 v91, v146
    v_exp_f16_sdwa v90, v145 dst_sel:WORD_1 dst_unused:UNUSED_PRESERVE src0_sel:WORD_0
    v_exp_f16_sdwa v91, v147 dst_sel:WORD_1 dst_unused:UNUSED_PRESERVE src0_sel:WORD_0
    v_exp_f16 v92, v148
    v_exp_f16 v93, v150
    v_exp_f16_sdwa v92, v149 dst_sel:WORD_1 dst_unused:UNUSED_PRESERVE src0_sel:WORD_0
    v_exp_f16_sdwa v93, v151 dst_sel:WORD_1 dst_unused:UNUSED_PRESERVE src0_sel:WORD_0
    v_mfma_f32_32x32x16_f16 v[196:211], v[72:75], v[84:87], v[196:211]
    s_cselect_b32 s50, 0, s50
    v_mov_b32 v6, v7
    v_lshl_add_u32 v7, v1, 4, s50
    v_exp_f16 v94, v152
    v_exp_f16 v95, v154
    v_exp_f16_sdwa v94, v153 dst_sel:WORD_1 dst_unused:UNUSED_PRESERVE src0_sel:WORD_0
    v_exp_f16_sdwa v95, v155 dst_sel:WORD_1 dst_unused:UNUSED_PRESERVE src0_sel:WORD_0
    v_mfma_f32_32x32x16_f16 v[196:211], v[80:83], v[88:91], v[196:211]
    s_add_u32 s49, s49, 1
    v_exp_f16 v96, v156
    v_exp_f16 v97, v158
    v_exp_f16_sdwa v96, v157 dst_sel:WORD_1 dst_unused:UNUSED_PRESERVE src0_sel:WORD_0
    v_exp_f16_sdwa v97, v159 dst_sel:WORD_1 dst_unused:UNUSED_PRESERVE src0_sel:WORD_0
    v_mfma_f32_32x32x16_f16 v[132:147], v[60:63], v[44:47], 0
    s_cmp_lt_u32 s49, 8
    v_exp_f16 v98, v160
    v_exp_f16 v99, v162
    v_exp_f16_sdwa v98, v161 dst_sel:WORD_1 dst_unused:UNUSED_PRESERVE src0_sel:WORD_0
    v_exp_f16_sdwa v99, v163 dst_sel:WORD_1 dst_unused:UNUSED_PRESERVE src0_sel:WORD_0
    v_mfma_f32_32x32x16_f16 v[148:163], v[60:63], v[48:51], 0
    s_cbranch_scc1 L_loop
    v_mfma_f32_32x32x16_f16 v[212:227], v[72:75], v[92:95], v[212:227]
    v_mfma_f32_32x32x16_f16 v[212:227], v[80:83], v[96:99], v[212:227]
    ds_read_b32 v14, v14 offset:0
    v_add_f32 v16, |v164|, |v165|
    v_add_f32 v16, |v166|, v16
    v_add_f32 v16, |v167|, v16
    v_add_f32 v16, |v168|, v16
    v_add_f32 v16, |v169|, v16
    v_add_f32 v16, |v170|, v16
    v_add_f32 v16, |v171|, v16
    v_add_f32 v16, |v172|, v16
    v_add_f32 v16, |v173|, v16
    v_cmp_class_f32 vcc, v16, s46
    s_waitcnt lgkmcnt(0)
    v_readfirstlane_b32 s42, v14
    s_or_b64 s[40:41], s[40:41], vcc
    s_nop 0
    s_or_b32 s42, s42, s40
    s_or_b32 s42, s42, s41
    s_cbranch_scc1 L_generic
    v_rcp_f32 v20, v174
    s_nop 0
    v_pk_mul_f32 v[164:165], v[164:165], v[20:21] op_sel_hi:[1,0]
    v_pk_mul_f32 v[166:167], v[166:167], v[20:21] op_sel_hi:[1,0]
    v_pk_mul_f32 v[168:169], v[168:169], v[20:21] op_sel_hi:[1,0]
    v_pk_mul_f32 v[170:171], v[170:171], v[20:21] op_sel_hi:[1,0]
    v_pk_mul_f32 v[172:173], v[172:173], v[20:21] op_sel_hi:[1,0]
    v_cvt_pk_bf16_f32 v84, v164, v165
    v_cvt_pk_bf16_f32 v85, v166, v167
    v_cvt_pk_bf16_f32 v86, v168, v169
    v_cvt_pk_bf16_f32 v87, v170, v171
    v_cvt_pk_bf16_f32 v88, v172, v173
    buffer_store_dwordx4 v[84:87], v15, s[28:31], s37 offen offset:0
    buffer_store_dword v88, v28, s[28:31], s37 offen offset:16
    v_rcp_f32 v22, v190
    s_nop 0
    v_pk_mul_f32 v[180:181], v[180:181], v[22:23] op_sel_hi:[1,0]
    v_pk_mul_f32 v[182:183], v[182:183], v[22:23] op_sel_hi:[1,0]
    v_pk_mul_f32 v[184:185], v[184:185], v[22:23] op_sel_hi:[1,0]
    v_pk_mul_f32 v[186:187], v[186:187], v[22:23] op_sel_hi:[1,0]
    v_pk_mul_f32 v[188:189], v[188:189], v[22:23] op_sel_hi:[1,0]
    v_cvt_pk_bf16_f32 v92, v180, v181
    v_cvt_pk_bf16_f32 v93, v182, v183
    v_cvt_pk_bf16_f32 v94, v184, v185
    v_cvt_pk_bf16_f32 v95, v186, v187
    v_cvt_pk_bf16_f32 v96, v188, v189
    buffer_store_dwordx4 v[92:95], v15, s[28:31], s37 offen offset:1152
    buffer_store_dword v96, v28, s[28:31], s37 offen offset:1168
    v_rcp_f32 v20, v206
    s_nop 0
    v_pk_mul_f32 v[196:197], v[196:197], v[20:21] op_sel_hi:[1,0]
    v_pk_mul_f32 v[198:199], v[198:199], v[20:21] op_sel_hi:[1,0]
    v_pk_mul_f32 v[200:201], v[200:201], v[20:21] op_sel_hi:[1,0]
    v_pk_mul_f32 v[202:203], v[202:203], v[20:21] op_sel_hi:[1,0]
    v_pk_mul_f32 v[204:205], v[204:205], v[20:21] op_sel_hi:[1,0]
    v_cvt_pk_bf16_f32 v52, v196, v197
    v_cvt_pk_bf16_f32 v53, v198, v199
    v_cvt_pk_bf16_f32 v54, v200, v201
    v_cvt_pk_bf16_f32 v55, v202, v203
    v_cvt_pk_bf16_f32 v56, v204, v205
    buffer_store_dwordx4 v[52:55], v15, s[28:31], s37 offen offset:2304
    buffer_store_dword v56, v28, s[28:31], s37 offen offset:2320
    v_rcp_f32 v22, v222
    s_nop 0
    v_pk_mul_f32 v[212:213], v[212:213], v[22:23] op_sel_hi:[1,0]
    v_pk_mul_f32 v[214:215], v[214:215], v[22:23] op_sel_hi:[1,0]
    v_pk_mul_f32 v[216:217], v[216:217], v[22:23] op_sel_hi:[1,0]
    v_pk_mul_f32 v[218:219], v[218:219], v[22:23] op_sel_hi:[1,0]
    v_pk_mul_f32 v[220:221], v[220:221], v[22:23] op_sel_hi:[1,0]
    v_cvt_pk_bf16_f32 v60, v212, v213
    v_cvt_pk_bf16_f32 v61, v214, v215
    v_cvt_pk_bf16_f32 v62, v216, v217
    v_cvt_pk_bf16_f32 v63, v218, v219
    v_cvt_pk_bf16_f32 v64, v220, v221
    buffer_store_dwordx4 v[60:63], v15, s[28:31], s37 offen offset:3456
    buffer_store_dword v64, v28, s[28:31], s37 offen offset:3472
L_end:
    s_endpgm
L_producer:
    s_setprio 3
    s_mov_b32 s44, 0xffff0000
    s_mov_b32 s45, 0x358637bd
    s_mov_b32 s46, 0x207
    s_mov_b64 s[40:41], 0
    v_mov_b32 v14, 0x15000
    s_mov_b32 s47, 0x3b000000
    s_mov_b32 s54, 0x0003ffff
    s_mov_b32 s55, 0x0003ffff
    s_mul_i32 s51, s52, 7168
    v_lshrrev_b32 v17, 5, v1
    v_lshl_add_u32 v5, v1, 4, s51
    v_and_b32 v16, 31, v1
    v_lshl_add_u32 v18, v16, 4, s51
    v_lshl_add_u32 v8, v17, 10, v18
    v_lshl_add_u32 v9, v17, 3, v18
    v_mov_b32 v232, 0
    v_mov_b32 v233, 0
    v_mov_b32 v234, 0
    v_mov_b32 v235, 0
    v_mov_b32 v228, 0
    v_mov_b32 v229, 0
    s_mov_b32 s38, 0x3f80
    s_mov_b32 s39, 0x3f800000
    v_writelane_b32 v232, s38, 0
    v_writelane_b32 v232, s39, 1
    v_writelane_b32 v233, s38, 2
    v_writelane_b32 v233, s39, 3
    v_writelane_b32 v234, s38, 8
    v_writelane_b32 v234, s39, 9
    v_writelane_b32 v235, s38, 10
    v_writelane_b32 v235, s39, 11
    v_writelane_b32 v232, s38, 48
    v_writelane_b32 v232, s39, 49
    v_writelane_b32 v233, s38, 36
    v_writelane_b32 v233, s39, 37
    v_writelane_b32 v234, s38, 38
    v_writelane_b32 v234, s39, 39
    v_writelane_b32 v235, s38, 44
    v_writelane_b32 v235, s39, 45
    v_writelane_b32 v228, s38, 14
    v_writelane_b32 v228, s38, 46
    v_writelane_b32 v228, s39, 15
    v_writelane_b32 v228, s39, 47
    v_writelane_b32 v229, s38, 18
    v_writelane_b32 v229, s38, 50
    v_writelane_b32 v229, s38, 22
    v_writelane_b32 v229, s38, 54
    v_mov_b32 v185, 0x3f80
    v_mov_b32 v133, 0x3f80
    v_mov_b32 v109, 0x5ae05a00
    v_mov_b32 v173, 0
    s_mov_b32 s56, 0xaaaaaaaa
    s_mov_b32 s57, 0xaaaaaaaa
    s_mov_b32 s58, 0xcccccccc
    s_mov_b32 s59, 0xcccccccc
    v_mov_b32 v18, 0x3f80
    v_mov_b32 v19, 0x3f800000
    v_cndmask_b32 v18, v18, v19, s[56:57]
    v_mov_b32 v17, 0
    v_cndmask_b32 v160, v18, v17, s[58:59]
    v_cndmask_b32 v161, v17, v18, s[58:59]
    ds_write_b32 v14, v17 offset:0
    v_add_u32 v10, 0, v8
    v_add_u32 v11, 0, v9
    v_add_u32 v12, 0, v5
    s_waitcnt vmcnt(5)
    v_mfma_f32_32x32x16_bf16 v[188:203], v[124:127], v[232:235], 0
    s_waitcnt vmcnt(4)
    v_mfma_f32_32x32x16_bf16 v[204:219], v[128:131], v[232:235], 0
    s_waitcnt vmcnt(2)
    v_dot2_f32_bf16 v16, v112, v112, 0
    v_dot2_f32_bf16 v17, v113, v113, 0
    v_dot2_f32_bf16 v16, v114, v114, v16
    v_dot2_f32_bf16 v17, v115, v115, v17
    s_waitcnt vmcnt(1)
    v_dot2_f32_bf16 v16, v116, v116, v16
    v_dot2_f32_bf16 v17, v117, v117, v17
    v_dot2_f32_bf16 v16, v118, v118, v16
    v_dot2_f32_bf16 v17, v119, v119, v17
    s_waitcnt vmcnt(0)
    v_dot2_f32_bf16 v16, v120, v120, v16
    v_lshlrev_b32 v20, 16, v112
    v_mfma_f32_32x32x4_2b_bf16 v[188:219], v[132:133], v[228:229], v[188:219]
    v_and_b32 v21, s44, v112
    v_lshlrev_b32 v22, 16, v113
    v_and_b32 v23, s44, v113
    v_add_f32 v16, v16, v17
    v_sqrt_f32 v18, v16
    v_cmp_class_f32 vcc, v16, s46
    v_add_f32 v18, s45, v18
    v_rcp_f32 v18, v18
    v_lshlrev_b32 v24, 16, v114
    v_and_b32 v25, s44, v114
    s_or_b64 s[40:41], s[40:41], vcc
    v_pk_mul_f32 v[20:21], v[20:21], v[18:19] op_sel_hi:[1,0]
    v_lshlrev_b32 v26, 16, v115
    v_and_b32 v27, s44, v115
    v_cvt_pk_f16_f32 v100, v20, v21
    v_pk_mul_f32 v[22:23], v[22:23], v[18:19] op_sel_hi:[1,0]
    v_lshlrev_b32 v20, 16, v116
    v_and_b32 v21, s44, v116
    v_cvt_pk_f16_f32 v101, v22, v23
    v_pk_mul_f32 v[24:25], v[24:25], v[18:19] op_sel_hi:[1,0]
    v_lshlrev_b32 v22, 16, v117
    v_and_b32 v23, s44, v117
    v_cvt_pk_f16_f32 v102, v24, v25
    v_pk_mul_f32 v[26:27], v[26:27], v[18:19] op_sel_hi:[1,0]
    v_lshlrev_b32 v24, 16, v118
    v_and_b32 v25, s44, v118
    v_cvt_pk_f16_f32 v103, v26, v27
    v_pk_mul_f32 v[20:21], v[20:21], v[18:19] op_sel_hi:[1,0]
    v_lshlrev_b32 v26, 16, v119
    v_and_b32 v27, s44, v119
    v_cvt_pk_f16_f32 v104, v20, v21
    v_pk_mul_f32 v[22:23], v[22:23], v[18:19] op_sel_hi:[1,0]
    v_lshlrev_b32 v20, 16, v120
    v_and_b32 v21, s44, v120
    v_cvt_pk_f16_f32 v105, v22, v23
    v_pk_mul_f32 v[24:25], v[24:25], v[18:19] op_sel_hi:[1,0]
    v_cvt_pk_f16_f32 v106, v24, v25
    v_pk_mul_f32 v[26:27], v[26:27], v[18:19] op_sel_hi:[1,0]
    v_cvt_pk_f16_f32 v107, v26, v27
    v_pk_mul_f32 v[20:21], v[20:21], v[18:19] op_sel_hi:[1,0]
    v_cvt_pk_f16_f32 v108, v20, v21
    v_cvt_pk_f16_f32 v188, v188, v189
    v_cvt_pk_f16_f32 v189, v190, v191
    v_cvt_pk_f16_f32 v190, v192, v193
    v_cvt_pk_f16_f32 v191, v194, v195
    v_cvt_pk_f16_f32 v196, v196, v197
    v_cvt_pk_f16_f32 v197, v198, v199
    v_cvt_pk_f16_f32 v198, v200, v201
    v_cvt_pk_f16_f32 v199, v202, v203
    v_cvt_pk_f16_f32 v204, v204, v205
    v_cvt_pk_f16_f32 v205, v206, v207
    v_cvt_pk_f16_f32 v206, v208, v209
    v_cvt_pk_f16_f32 v207, v210, v211
    v_cvt_pk_f16_f32 v212, v212, v213
    v_cvt_pk_f16_f32 v213, v214, v215
    v_cvt_pk_f16_f32 v214, v216, v217
    v_cvt_pk_f16_f32 v215, v218, v219
    ds_write_b128 v10, v[100:103] offset:0
    ds_write_b128 v10, v[104:107] offset:512
    ds_write_b64 v11, v[108:109] offset:2048
    ds_write_b64 v11, v[108:109] offset:2560
    ds_write_b128 v12, v[188:191] offset:3072
    ds_write_b128 v12, v[196:199] offset:4096
    ds_write_b128 v12, v[204:207] offset:5120
    ds_write_b128 v12, v[212:215] offset:6144
    s_waitcnt lgkmcnt(0)
    s_lshl_b32 s38, s35, 16
    s_and_b32 s39, s35, 0xffff0000
    s_bitcmp1_b32 s32, 0
    s_cselect_b32 s35, s39, s38
    v_mov_b32 v13, 0x3fb8aa3b
    v_mul_f32 v13, s35, v13
    s_and_b32 s38, s35, 0x7fffffff
    s_cmp_gt_u32 s38, 0x402f0000
    s_cbranch_scc1 L_end2
    s_barrier
    buffer_load_dwordx4 v[176:179], v3, s[24:27], s48 offen offset:0
    buffer_load_dwordx4 v[180:183], v3, s[24:27], s48 offen offset:1152
    buffer_load_dword v184, v2, s[24:27], s48 offen offset:32
    buffer_load_dwordx4 v[164:167], v2, s[20:23], s48 offen offset:0
    buffer_load_dwordx4 v[168:171], v2, s[20:23], s48 offen offset:16
    buffer_load_dword v172, v2, s[20:23], s48 offen offset:32
    s_mov_b32 s49, 1
    s_mov_b32 s50, 28672
    s_add_u32 s43, s48, 9216
    s_waitcnt vmcnt(5)
    v_mfma_f32_32x32x16_bf16 v[188:203], v[176:179], v[232:235], 0
    s_waitcnt vmcnt(4)
    v_mfma_f32_32x32x16_bf16 v[204:219], v[180:183], v[232:235], 0
    s_waitcnt vmcnt(3)
    s_nop 8
    v_mfma_f32_32x32x4_2b_bf16 v[188:219], v[184:185], v[228:229], v[188:219]
    buffer_load_dwordx4 v[176:179], v3, s[24:27], s43 offen offset:0
    buffer_load_dwordx4 v[180:183], v3, s[24:27], s43 offen offset:1152
    buffer_load_dword v184, v2, s[24:27], s43 offen offset:32
    s_nop 15
    s_nop 0
    v_max_f32 v16, |v188|, |v189|
    v_max3_f32 v16, |v190|, |v191|, v16
    v_max3_f32 v16, |v192|, |v193|, v16
    v_max3_f32 v16, |v194|, |v195|, v16
    v_max3_f32 v16, |v196|, |v197|, v16
    v_max3_f32 v16, |v198|, |v199|, v16
    v_max3_f32 v16, |v200|, |v201|, v16
    v_max3_f32 v16, |v202|, |v203|, v16
    v_max3_f32 v16, |v204|, |v205|, v16
    v_max3_f32 v16, |v206|, |v207|, v16
    v_max3_f32 v16, |v208|, |v209|, v16
    v_max3_f32 v16, |v210|, |v211|, v16
    v_max3_f32 v16, |v212|, |v213|, v16
    v_max3_f32 v16, |v214|, |v215|, v16
    v_max3_f32 v16, |v216|, |v217|, v16
    v_max3_f32 v16, |v218|, |v219|, v16
    v_cmp_gt_f32 vcc, s47, v16
    s_nop 1
    s_and_b64 vcc, vcc, s[54:55]
    s_or_b64 s[40:41], s[40:41], vcc
    s_nop 3
L_ploop:
    v_add_u32 v10, s50, v8
    v_add_u32 v11, s50, v9
    v_add_u32 v12, s50, v5
    s_waitcnt vmcnt(5)
    v_mfma_f32_4x4x4_16b_bf16 v[156:159], v[164:165], v[164:165], 0
    v_cvt_pk_f16_f32 v32, v188, v189
    v_mfma_f32_4x4x4_16b_bf16 v[136:139], v[160:161], v[164:165], 0
    v_cvt_pk_f16_f32 v33, v190, v191
    v_cvt_pk_f16_f32 v34, v192, v193
    v_mfma_f32_4x4x4_16b_bf16 v[156:159], v[166:167], v[166:167], v[156:159]
    v_cvt_pk_f16_f32 v35, v194, v195
    v_mfma_f32_4x4x4_16b_bf16 v[140:143], v[160:161], v[166:167], 0
    v_cvt_pk_f16_f32 v36, v196, v197
    v_cvt_pk_f16_f32 v37, v198, v199
    ds_write_b128 v12, v[32:35] offset:3072
    s_waitcnt vmcnt(4)
    v_mfma_f32_4x4x4_16b_bf16 v[156:159], v[168:169], v[168:169], v[156:159]
    v_cvt_pk_f16_f32 v38, v200, v201
    v_mfma_f32_4x4x4_16b_bf16 v[144:147], v[160:161], v[168:169], 0
    v_cvt_pk_f16_f32 v39, v202, v203
    v_cvt_pk_f16_f32 v40, v204, v205
    ds_write_b128 v12, v[36:39] offset:4096
    v_mfma_f32_4x4x4_16b_bf16 v[156:159], v[170:171], v[170:171], v[156:159]
    v_cvt_pk_f16_f32 v41, v206, v207
    v_mfma_f32_4x4x4_16b_bf16 v[148:151], v[160:161], v[170:171], 0
    v_cvt_pk_f16_f32 v42, v208, v209
    v_cvt_pk_f16_f32 v43, v210, v211
    s_waitcnt vmcnt(3)
    v_mfma_f32_4x4x4_16b_bf16 v[156:159], v[172:173], v[172:173], v[156:159]
    v_cvt_pk_f16_f32 v44, v212, v213
    v_mfma_f32_4x4x4_16b_bf16 v[152:155], v[160:161], v[172:173], 0
    v_cvt_pk_f16_f32 v45, v214, v215
    v_cvt_pk_f16_f32 v46, v216, v217
    ds_write_b128 v12, v[40:43] offset:5120
    v_cvt_pk_f16_f32 v47, v218, v219
    ds_write_b128 v12, v[44:47] offset:6144
    s_add_u32 s48, s48, 9216
    s_cmp_ge_u32 s49, 7
    s_cselect_b32 s48, 0x40000000, s48
    buffer_load_dwordx4 v[164:167], v2, s[20:23], s48 offen offset:0
    buffer_load_dwordx4 v[168:171], v2, s[20:23], s48 offen offset:16
    buffer_load_dword v172, v2, s[20:23], s48 offen offset:32
    v_cndmask_b32 v16, v156, v157, s[56:57]
    s_waitcnt vmcnt(5)
    v_mfma_f32_32x32x16_bf16 v[188:203], v[176:179], v[232:235], 0
    v_cndmask_b32 v17, v158, v159, s[56:57]
    v_cndmask_b32 v16, v16, v17, s[58:59]
    v_sqrt_f32 v18, v16
    v_cmp_class_f32 vcc, v16, s46
    v_add_f32 v18, s45, v18
    v_rcp_f32 v18, v18
    s_or_b64 s[40:41], s[40:41], vcc
    s_waitcnt vmcnt(4)
    v_mfma_f32_32x32x16_bf16 v[204:219], v[180:183], v[232:235], 0
    v_mul_f32 v136, v136, v18
    v_mul_f32 v137, v137, v18
    v_cvt_pk_f16_f32 v100, v136, v137
    v_mul_f32 v138, v138, v18
    v_mul_f32 v139, v139, v18
    v_cvt_pk_f16_f32 v101, v138, v139
    v_mul_f32 v140, v140, v18
    v_mul_f32 v141, v141, v18
    v_cvt_pk_f16_f32 v102, v140, v141
    v_mul_f32 v142, v142, v18
    s_waitcnt vmcnt(3)
    v_mfma_f32_32x32x4_2b_bf16 v[188:219], v[184:185], v[228:229], v[188:219]
    v_mul_f32 v143, v143, v18
    v_cvt_pk_f16_f32 v103, v142, v143
    v_mul_f32 v144, v144, v18
    ds_write_b128 v10, v[100:103] offset:0
    v_mul_f32 v145, v145, v18
    v_cvt_pk_f16_f32 v104, v144, v145
    v_mul_f32 v146, v146, v18
    v_mul_f32 v147, v147, v18
    v_cvt_pk_f16_f32 v105, v146, v147
    v_mul_f32 v148, v148, v18
    v_mul_f32 v149, v149, v18
    v_cvt_pk_f16_f32 v106, v148, v149
    v_mul_f32 v150, v150, v18
    v_mul_f32 v151, v151, v18
    v_cvt_pk_f16_f32 v107, v150, v151
    v_mul_f32 v152, v152, v18
    v_mul_f32 v153, v153, v18
    v_cvt_pk_f16_f32 v108, v152, v153
    ds_write_b128 v10, v[104:107] offset:512
    ds_write_b64 v11, v[108:109] offset:2048
    ds_write_b64 v11, v[108:109] offset:2560
    s_add_u32 s43, s43, 9216
    s_cmp_ge_u32 s49, 6
    s_cselect_b32 s43, 0x40000000, s43
    buffer_load_dwordx4 v[176:179], v3, s[24:27], s43 offen offset:0
    buffer_load_dwordx4 v[180:183], v3, s[24:27], s43 offen offset:1152
    buffer_load_dword v184, v2, s[24:27], s43 offen offset:32
    s_cmp_lg_u32 s49, 7
    s_cbranch_scc1 L_pnoflag
    s_or_b32 s42, s40, s41
    v_mov_b32 v17, s42
    ds_or_b32 v14, v17 offset:0
L_pnoflag:
    s_waitcnt lgkmcnt(0)
    s_barrier
    s_add_u32 s50, s50, 28672
    s_cmp_ge_u32 s50, 86016
    s_cselect_b32 s50, 0, s50
    s_add_u32 s49, s49, 1
    s_cmp_lt_u32 s49, 8
    s_nop 7
    s_cbranch_scc1 L_ploop
L_end2:
    s_endpgm
L_generic:
    s_waitcnt vmcnt(0) lgkmcnt(0)
    s_nop 15
    s_nop 5
    v_mul_u32_u24 v2, 36, v1
    v_and_b32 v16, 31, v1
    v_mul_u32_u24 v3, 36, v16
    v_lshrrev_b32 v17, 5, v1
    v_lshl_add_u32 v3, v17, 4, v3
    v_mov_b32 v185, 0x3f80
    v_mov_b32 v232, 0
    v_mov_b32 v233, 0
    v_mov_b32 v234, 0
    v_mov_b32 v235, 0
    v_mov_b32 v228, 0
    v_mov_b32 v229, 0
    s_mov_b32 s38, 0x3f80
    s_mov_b32 s39, 0x3f800000
    v_writelane_b32 v232, s38, 0
    v_writelane_b32 v232, s39, 1
    v_writelane_b32 v233, s38, 2
    v_writelane_b32 v233, s39, 3
    v_writelane_b32 v234, s38, 8
    v_writelane_b32 v234, s39, 9
    v_writelane_b32 v235, s38, 10
    v_writelane_b32 v235, s39, 11
    v_writelane_b32 v232, s38, 48
    v_writelane_b32 v232, s39, 49
    v_writelane_b32 v233, s38, 36
    v_writelane_b32 v233, s39, 37
    v_writelane_b32 v234, s38, 38
    v_writelane_b32 v234, s39, 39
    v_writelane_b32 v235, s38, 44
    v_writelane_b32 v235, s39, 45
    v_writelane_b32 v228, s38, 14
    v_writelane_b32 v228, s38, 46
    v_writelane_b32 v228, s39, 15
    v_writelane_b32 v228, s39, 47
    v_writelane_b32 v229, s38, 18
    v_writelane_b32 v229, s38, 50
    v_writelane_b32 v229, s38, 22
    v_writelane_b32 v229, s38, 54
    s_mov_b32 s43, 0
    s_waitcnt vmcnt(0) lgkmcnt(0)
    s_nop 15
    s_nop 5
L_g_half:
    buffer_load_dwordx4 v[164:167], v4, s[16:19], s37 offen offset:0
    buffer_load_dwordx4 v[168:171], v4, s[16:19], s37 offen offset:16
    buffer_load_dword v172, v4, s[16:19], s37 offen offset:32
    s_waitcnt vmcnt(2)
    v_dot2_f32_bf16 v16, v164, v164, 0
    v_dot2_f32_bf16 v17, v165, v165, 0
    v_dot2_f32_bf16 v16, v166, v166, v16
    v_dot2_f32_bf16 v17, v167, v167, v17
    s_waitcnt vmcnt(1)
    v_dot2_f32_bf16 v16, v168, v168, v16
    v_dot2_f32_bf16 v17, v169, v169, v17
    v_dot2_f32_bf16 v16, v170, v170, v16
    v_dot2_f32_bf16 v17, v171, v171, v17
    s_waitcnt vmcnt(0)
    v_dot2_f32_bf16 v16, v172, v172, v16
    v_lshlrev_b32 v20, 16, v164
    v_and_b32 v21, s44, v164
    v_lshlrev_b32 v22, 16, v165
    v_and_b32 v23, s44, v165
    v_add_f32 v16, v16, v17
    v_sqrt_f32 v18, v16
    v_lshlrev_b32 v24, 16, v166
    v_and_b32 v25, s44, v166
    v_add_f32 v18, s45, v18
    v_rcp_f32 v18, v18
    s_nop 0
    v_pk_mul_f32 v[20:21], v[20:21], v[18:19] op_sel_hi:[1,0]
    v_lshlrev_b32 v26, 16, v167
    v_and_b32 v27, s44, v167
    v_cvt_pk_f16_f32 v36, v20, v21
    v_pk_mul_f32 v[22:23], v[22:23], v[18:19] op_sel_hi:[1,0]
    v_lshlrev_b32 v20, 16, v168
    v_and_b32 v21, s44, v168
    v_cvt_pk_f16_f32 v37, v22, v23
    v_pk_mul_f32 v[24:25], v[24:25], v[18:19] op_sel_hi:[1,0]
    v_lshlrev_b32 v22, 16, v169
    v_and_b32 v23, s44, v169
    v_cvt_pk_f16_f32 v38, v24, v25
    v_pk_mul_f32 v[26:27], v[26:27], v[18:19] op_sel_hi:[1,0]
    v_lshlrev_b32 v24, 16, v170
    v_and_b32 v25, s44, v170
    v_cvt_pk_f16_f32 v39, v26, v27
    v_pk_mul_f32 v[20:21], v[20:21], v[18:19] op_sel_hi:[1,0]
    v_lshlrev_b32 v26, 16, v171
    v_and_b32 v27, s44, v171
    v_cvt_pk_f16_f32 v40, v20, v21
    v_pk_mul_f32 v[22:23], v[22:23], v[18:19] op_sel_hi:[1,0]
    v_lshlrev_b32 v20, 16, v172
    v_and_b32 v21, s44, v172
    v_cvt_pk_f16_f32 v41, v22, v23
    v_pk_mul_f32 v[24:25], v[24:25], v[18:19] op_sel_hi:[1,0]
    v_cvt_pk_f16_f32 v42, v24, v25
    v_pk_mul_f32 v[26:27], v[26:27], v[18:19] op_sel_hi:[1,0]
    v_cvt_pk_f16_f32 v43, v26, v27
    v_pk_mul_f32 v[20:21], v[20:21], v[18:19] op_sel_hi:[1,0]
    v_cvt_pk_f16_f32 v32, v20, v21
    v_mov_b32 v33, 0x00000000
    v_permlane32_swap_b32 v36, v40
    v_permlane32_swap_b32 v37, v41
    v_permlane32_swap_b32 v38, v42
    v_permlane32_swap_b32 v39, v43
    v_mov_b32 v132, 0
    v_mov_b32 v133, 0
    v_mov_b32 v134, 0
    v_mov_b32 v135, 0
    v_mov_b32 v136, 0
    v_mov_b32 v137, 0
    v_mov_b32 v138, 0
    v_mov_b32 v139, 0
    v_mov_b32 v140, 0
    v_mov_b32 v141, 0
    v_mov_b32 v142, 0
    v_mov_b32 v143, 0
    v_mov_b32 v144, 0
    v_mov_b32 v145, 0
    v_mov_b32 v146, 0
    v_mov_b32 v147, 0
    v_mov_b32 v148, 0
    v_mov_b32 v149, 0
    v_mov_b32 v150, 0
    v_mov_b32 v151, 0
    v_mov_b32 v152, 0
    v_mov_b32 v153, 0
    v_mov_b32 v154, 0
    v_mov_b32 v155, 0
    v_mov_b32 v156, 0
    v_mov_b32 v157, 0
    v_mov_b32 v158, 0
    v_mov_b32 v159, 0
    v_mov_b32 v160, 0
    v_mov_b32 v161, 0
    v_mov_b32 v162, 0
    v_mov_b32 v163, 0
    v_mov_b32 v29, 0xff7fffff
    v_mov_b32 v30, 0xff7fffff
    s_mov_b32 s48, s36
    s_mov_b32 s49, 0
    s_waitcnt vmcnt(0) lgkmcnt(0)
    s_nop 15
    s_nop 5
L_g_pair:
    buffer_load_dwordx4 v[164:167], v2, s[20:23], s48 offen offset:0
    buffer_load_dwordx4 v[168:171], v2, s[20:23], s48 offen offset:16
    buffer_load_dword v172, v2, s[20:23], s48 offen offset:32
    buffer_load_dwordx4 v[176:179], v3, s[24:27], s48 offen offset:0
    buffer_load_dwordx4 v[180:183], v3, s[24:27], s48 offen offset:1152
    buffer_load_dword v184, v2, s[24:27], s48 offen offset:32
    s_waitcnt vmcnt(5)
    v_dot2_f32_bf16 v16, v164, v164, 0
    v_dot2_f32_bf16 v17, v165, v165, 0
    v_dot2_f32_bf16 v16, v166, v166, v16
    v_dot2_f32_bf16 v17, v167, v167, v17
    s_waitcnt vmcnt(4)
    v_dot2_f32_bf16 v16, v168, v168, v16
    v_dot2_f32_bf16 v17, v169, v169, v17
    v_dot2_f32_bf16 v16, v170, v170, v16
    v_dot2_f32_bf16 v17, v171, v171, v17
    s_waitcnt vmcnt(3)
    v_dot2_f32_bf16 v16, v172, v172, v16
    v_lshlrev_b32 v20, 16, v164
    v_and_b32 v21, s44, v164
    v_lshlrev_b32 v22, 16, v165
    v_and_b32 v23, s44, v165
    v_add_f32 v16, v16, v17
    v_sqrt_f32 v18, v16
    v_lshlrev_b32 v24, 16, v166
    v_and_b32 v25, s44, v166
    v_add_f32 v18, s45, v18
    v_rcp_f32 v18, v18
    s_nop 0
    v_pk_mul_f32 v[20:21], v[20:21], v[18:19] op_sel_hi:[1,0]
    v_lshlrev_b32 v26, 16, v167
    v_and_b32 v27, s44, v167
    v_cvt_pk_f16_f32 v60, v20, v21
    v_pk_mul_f32 v[22:23], v[22:23], v[18:19] op_sel_hi:[1,0]
    v_lshlrev_b32 v20, 16, v168
    v_and_b32 v21, s44, v168
    v_cvt_pk_f16_f32 v61, v22, v23
    v_pk_mul_f32 v[24:25], v[24:25], v[18:19] op_sel_hi:[1,0]
    v_lshlrev_b32 v22, 16, v169
    v_and_b32 v23, s44, v169
    v_cvt_pk_f16_f32 v62, v24, v25
    v_pk_mul_f32 v[26:27], v[26:27], v[18:19] op_sel_hi:[1,0]
    v_lshlrev_b32 v24, 16, v170
    v_and_b32 v25, s44, v170
    v_cvt_pk_f16_f32 v63, v26, v27
    v_pk_mul_f32 v[20:21], v[20:21], v[18:19] op_sel_hi:[1,0]
    v_lshlrev_b32 v26, 16, v171
    v_and_b32 v27, s44, v171
    v_cvt_pk_f16_f32 v64, v20, v21
    v_pk_mul_f32 v[22:23], v[22:23], v[18:19] op_sel_hi:[1,0]
    v_lshlrev_b32 v20, 16, v172
    v_and_b32 v21, s44, v172
    v_cvt_pk_f16_f32 v65, v22, v23
    v_pk_mul_f32 v[24:25], v[24:25], v[18:19] op_sel_hi:[1,0]
    v_cvt_pk_f16_f32 v66, v24, v25
    v_pk_mul_f32 v[26:27], v[26:27], v[18:19] op_sel_hi:[1,0]
    v_cvt_pk_f16_f32 v67, v26, v27
    v_pk_mul_f32 v[20:21], v[20:21], v[18:19] op_sel_hi:[1,0]
    v_cvt_pk_f16_f32 v52, v20, v21
    v_mov_b32 v54, v52
    v_mov_b32 v53, 0
    v_mov_b32 v55, 0
    v_permlane32_swap_b32 v60, v64
    v_permlane32_swap_b32 v61, v65
    v_permlane32_swap_b32 v62, v66
    v_permlane32_swap_b32 v63, v67
    v_permlane32_swap_b32 v52, v54
    s_waitcnt vmcnt(2)
    v_mfma_f32_32x32x16_bf16 v[188:203], v[176:179], v[232:235], 0
    s_waitcnt vmcnt(1)
    v_mfma_f32_32x32x16_bf16 v[204:219], v[180:183], v[232:235], 0
    s_waitcnt vmcnt(0)
    s_nop 8
    v_mfma_f32_32x32x4_2b_bf16 v[188:219], v[184:185], v[228:229], v[188:219]
    s_nop 15
    s_nop 3
    v_cvt_pk_bf16_f32 v68, v188, v189
    v_cvt_pk_bf16_f32 v69, v190, v191
    v_cvt_pk_bf16_f32 v70, v192, v193
    v_cvt_pk_bf16_f32 v71, v194, v195
    v_cvt_pk_bf16_f32 v76, v196, v197
    v_cvt_pk_bf16_f32 v77, v198, v199
    v_cvt_pk_bf16_f32 v78, v200, v201
    v_cvt_pk_bf16_f32 v79, v202, v203
    v_cvt_pk_bf16_f32 v72, v204, v205
    v_cvt_pk_bf16_f32 v73, v206, v207
    v_cvt_pk_bf16_f32 v74, v208, v209
    v_cvt_pk_bf16_f32 v75, v210, v211
    v_cvt_pk_bf16_f32 v80, v212, v213
    v_cvt_pk_bf16_f32 v81, v214, v215
    v_cvt_pk_bf16_f32 v82, v216, v217
    v_cvt_pk_bf16_f32 v83, v218, v219
    v_mfma_f32_32x32x16_f16 v[100:115], v[60:63], v[36:39], 0
    v_mfma_f32_32x32x16_f16 v[116:131], v[60:63], v[40:43], 0
    s_nop 9
    v_mfma_f32_32x32x4_2b_f16 v[100:131], v[52:53], v[32:33], v[100:131]
    s_nop 15
    s_nop 3
    v_mul_f32 v100, v100, v13
    v_mul_f32 v101, v101, v13
    v_mul_f32 v102, v102, v13
    v_mul_f32 v103, v103, v13
    v_mul_f32 v104, v104, v13
    v_mul_f32 v105, v105, v13
    v_mul_f32 v106, v106, v13
    v_mul_f32 v107, v107, v13
    v_mul_f32 v108, v108, v13
    v_mul_f32 v109, v109, v13
    v_mul_f32 v110, v110, v13
    v_mul_f32 v111, v111, v13
    v_mul_f32 v112, v112, v13
    v_mul_f32 v113, v113, v13
    v_mul_f32 v114, v114, v13
    v_mul_f32 v115, v115, v13
    v_max_f32 v16, v100, v101
    v_max3_f32 v16, v102, v103, v16
    v_max3_f32 v16, v104, v105, v16
    v_max3_f32 v16, v106, v107, v16
    v_max3_f32 v16, v108, v109, v16
    v_max3_f32 v16, v110, v111, v16
    v_max3_f32 v16, v112, v113, v16
    v_max3_f32 v16, v114, v115, v16
    v_mov_b32 v17, v16
    s_nop 1
    v_permlane32_swap_b32 v16, v17
    s_nop 1
    v_max3_f32 v16, v16, v17, v29
    v_sub_f32 v17, v29, v16
    v_exp_f32 v17, v17
    v_mov_b32 v29, v16
    v_mul_f32 v132, v132, v17
    v_mul_f32 v133, v133, v17
    v_mul_f32 v134, v134, v17
    v_mul_f32 v135, v135, v17
    v_mul_f32 v136, v136, v17
    v_mul_f32 v137, v137, v17
    v_mul_f32 v138, v138, v17
    v_mul_f32 v139, v139, v17
    v_mul_f32 v140, v140, v17
    v_mul_f32 v141, v141, v17
    v_mul_f32 v142, v142, v17
    v_mul_f32 v143, v143, v17
    v_mul_f32 v144, v144, v17
    v_mul_f32 v145, v145, v17
    v_mul_f32 v146, v146, v17
    v_mul_f32 v147, v147, v17
    v_sub_f32 v100, v100, v16
    v_sub_f32 v101, v101, v16
    v_sub_f32 v102, v102, v16
    v_sub_f32 v103, v103, v16
    v_sub_f32 v104, v104, v16
    v_sub_f32 v105, v105, v16
    v_sub_f32 v106, v106, v16
    v_sub_f32 v107, v107, v16
    v_sub_f32 v108, v108, v16
    v_sub_f32 v109, v109, v16
    v_sub_f32 v110, v110, v16
    v_sub_f32 v111, v111, v16
    v_sub_f32 v112, v112, v16
    v_sub_f32 v113, v113, v16
    v_sub_f32 v114, v114, v16
    v_sub_f32 v115, v115, v16
    v_exp_f32 v100, v100
    v_exp_f32 v101, v101
    v_exp_f32 v102, v102
    v_exp_f32 v103, v103
    v_exp_f32 v104, v104
    v_exp_f32 v105, v105
    v_exp_f32 v106, v106
    v_exp_f32 v107, v107
    v_exp_f32 v108, v108
    v_exp_f32 v109, v109
    v_exp_f32 v110, v110
    v_exp_f32 v111, v111
    v_exp_f32 v112, v112
    v_exp_f32 v113, v113
    v_exp_f32 v114, v114
    v_exp_f32 v115, v115
    v_cvt_pk_bf16_f32 v84, v100, v101
    v_cvt_pk_bf16_f32 v85, v102, v103
    v_cvt_pk_bf16_f32 v86, v104, v105
    v_cvt_pk_bf16_f32 v87, v106, v107
    v_cvt_pk_bf16_f32 v88, v108, v109
    v_cvt_pk_bf16_f32 v89, v110, v111
    v_cvt_pk_bf16_f32 v90, v112, v113
    v_cvt_pk_bf16_f32 v91, v114, v115
    v_mfma_f32_32x32x16_bf16 v[132:147], v[68:71], v[84:87], v[132:147]
    s_nop 0
    v_mfma_f32_32x32x16_bf16 v[132:147], v[76:79], v[88:91], v[132:147]
    v_mul_f32 v116, v116, v13
    v_mul_f32 v117, v117, v13
    v_mul_f32 v118, v118, v13
    v_mul_f32 v119, v119, v13
    v_mul_f32 v120, v120, v13
    v_mul_f32 v121, v121, v13
    v_mul_f32 v122, v122, v13
    v_mul_f32 v123, v123, v13
    v_mul_f32 v124, v124, v13
    v_mul_f32 v125, v125, v13
    v_mul_f32 v126, v126, v13
    v_mul_f32 v127, v127, v13
    v_mul_f32 v128, v128, v13
    v_mul_f32 v129, v129, v13
    v_mul_f32 v130, v130, v13
    v_mul_f32 v131, v131, v13
    v_max_f32 v16, v116, v117
    v_max3_f32 v16, v118, v119, v16
    v_max3_f32 v16, v120, v121, v16
    v_max3_f32 v16, v122, v123, v16
    v_max3_f32 v16, v124, v125, v16
    v_max3_f32 v16, v126, v127, v16
    v_max3_f32 v16, v128, v129, v16
    v_max3_f32 v16, v130, v131, v16
    v_mov_b32 v17, v16
    s_nop 1
    v_permlane32_swap_b32 v16, v17
    s_nop 1
    v_max3_f32 v16, v16, v17, v30
    v_sub_f32 v17, v30, v16
    v_exp_f32 v17, v17
    v_mov_b32 v30, v16
    v_mul_f32 v148, v148, v17
    v_mul_f32 v149, v149, v17
    v_mul_f32 v150, v150, v17
    v_mul_f32 v151, v151, v17
    v_mul_f32 v152, v152, v17
    v_mul_f32 v153, v153, v17
    v_mul_f32 v154, v154, v17
    v_mul_f32 v155, v155, v17
    v_mul_f32 v156, v156, v17
    v_mul_f32 v157, v157, v17
    v_mul_f32 v158, v158, v17
    v_mul_f32 v159, v159, v17
    v_mul_f32 v160, v160, v17
    v_mul_f32 v161, v161, v17
    v_mul_f32 v162, v162, v17
    v_mul_f32 v163, v163, v17
    v_sub_f32 v116, v116, v16
    v_sub_f32 v117, v117, v16
    v_sub_f32 v118, v118, v16
    v_sub_f32 v119, v119, v16
    v_sub_f32 v120, v120, v16
    v_sub_f32 v121, v121, v16
    v_sub_f32 v122, v122, v16
    v_sub_f32 v123, v123, v16
    v_sub_f32 v124, v124, v16
    v_sub_f32 v125, v125, v16
    v_sub_f32 v126, v126, v16
    v_sub_f32 v127, v127, v16
    v_sub_f32 v128, v128, v16
    v_sub_f32 v129, v129, v16
    v_sub_f32 v130, v130, v16
    v_sub_f32 v131, v131, v16
    v_exp_f32 v116, v116
    v_exp_f32 v117, v117
    v_exp_f32 v118, v118
    v_exp_f32 v119, v119
    v_exp_f32 v120, v120
    v_exp_f32 v121, v121
    v_exp_f32 v122, v122
    v_exp_f32 v123, v123
    v_exp_f32 v124, v124
    v_exp_f32 v125, v125
    v_exp_f32 v126, v126
    v_exp_f32 v127, v127
    v_exp_f32 v128, v128
    v_exp_f32 v129, v129
    v_exp_f32 v130, v130
    v_exp_f32 v131, v131
    v_cvt_pk_bf16_f32 v92, v116, v117
    v_cvt_pk_bf16_f32 v93, v118, v119
    v_cvt_pk_bf16_f32 v94, v120, v121
    v_cvt_pk_bf16_f32 v95, v122, v123
    v_cvt_pk_bf16_f32 v96, v124, v125
    v_cvt_pk_bf16_f32 v97, v126, v127
    v_cvt_pk_bf16_f32 v98, v128, v129
    v_cvt_pk_bf16_f32 v99, v130, v131
    v_mfma_f32_32x32x16_bf16 v[148:163], v[68:71], v[92:95], v[148:163]
    s_nop 0
    v_mfma_f32_32x32x16_bf16 v[148:163], v[76:79], v[96:99], v[148:163]
    v_mfma_f32_32x32x16_f16 v[100:115], v[64:67], v[36:39], 0
    v_mfma_f32_32x32x16_f16 v[116:131], v[64:67], v[40:43], 0
    s_nop 9
    v_mfma_f32_32x32x4_2b_f16 v[100:131], v[54:55], v[32:33], v[100:131]
    s_nop 15
    s_nop 3
    v_mul_f32 v100, v100, v13
    v_mul_f32 v101, v101, v13
    v_mul_f32 v102, v102, v13
    v_mul_f32 v103, v103, v13
    v_mul_f32 v104, v104, v13
    v_mul_f32 v105, v105, v13
    v_mul_f32 v106, v106, v13
    v_mul_f32 v107, v107, v13
    v_mul_f32 v108, v108, v13
    v_mul_f32 v109, v109, v13
    v_mul_f32 v110, v110, v13
    v_mul_f32 v111, v111, v13
    v_mul_f32 v112, v112, v13
    v_mul_f32 v113, v113, v13
    v_mul_f32 v114, v114, v13
    v_mul_f32 v115, v115, v13
    v_max_f32 v16, v100, v101
    v_max3_f32 v16, v102, v103, v16
    v_max3_f32 v16, v104, v105, v16
    v_max3_f32 v16, v106, v107, v16
    v_max3_f32 v16, v108, v109, v16
    v_max3_f32 v16, v110, v111, v16
    v_max3_f32 v16, v112, v113, v16
    v_max3_f32 v16, v114, v115, v16
    v_mov_b32 v17, v16
    s_nop 1
    v_permlane32_swap_b32 v16, v17
    s_nop 1
    v_max3_f32 v16, v16, v17, v29
    v_sub_f32 v17, v29, v16
    v_exp_f32 v17, v17
    v_mov_b32 v29, v16
    v_mul_f32 v132, v132, v17
    v_mul_f32 v133, v133, v17
    v_mul_f32 v134, v134, v17
    v_mul_f32 v135, v135, v17
    v_mul_f32 v136, v136, v17
    v_mul_f32 v137, v137, v17
    v_mul_f32 v138, v138, v17
    v_mul_f32 v139, v139, v17
    v_mul_f32 v140, v140, v17
    v_mul_f32 v141, v141, v17
    v_mul_f32 v142, v142, v17
    v_mul_f32 v143, v143, v17
    v_mul_f32 v144, v144, v17
    v_mul_f32 v145, v145, v17
    v_mul_f32 v146, v146, v17
    v_mul_f32 v147, v147, v17
    v_sub_f32 v100, v100, v16
    v_sub_f32 v101, v101, v16
    v_sub_f32 v102, v102, v16
    v_sub_f32 v103, v103, v16
    v_sub_f32 v104, v104, v16
    v_sub_f32 v105, v105, v16
    v_sub_f32 v106, v106, v16
    v_sub_f32 v107, v107, v16
    v_sub_f32 v108, v108, v16
    v_sub_f32 v109, v109, v16
    v_sub_f32 v110, v110, v16
    v_sub_f32 v111, v111, v16
    v_sub_f32 v112, v112, v16
    v_sub_f32 v113, v113, v16
    v_sub_f32 v114, v114, v16
    v_sub_f32 v115, v115, v16
    v_exp_f32 v100, v100
    v_exp_f32 v101, v101
    v_exp_f32 v102, v102
    v_exp_f32 v103, v103
    v_exp_f32 v104, v104
    v_exp_f32 v105, v105
    v_exp_f32 v106, v106
    v_exp_f32 v107, v107
    v_exp_f32 v108, v108
    v_exp_f32 v109, v109
    v_exp_f32 v110, v110
    v_exp_f32 v111, v111
    v_exp_f32 v112, v112
    v_exp_f32 v113, v113
    v_exp_f32 v114, v114
    v_exp_f32 v115, v115
    v_cvt_pk_bf16_f32 v84, v100, v101
    v_cvt_pk_bf16_f32 v85, v102, v103
    v_cvt_pk_bf16_f32 v86, v104, v105
    v_cvt_pk_bf16_f32 v87, v106, v107
    v_cvt_pk_bf16_f32 v88, v108, v109
    v_cvt_pk_bf16_f32 v89, v110, v111
    v_cvt_pk_bf16_f32 v90, v112, v113
    v_cvt_pk_bf16_f32 v91, v114, v115
    v_mfma_f32_32x32x16_bf16 v[132:147], v[72:75], v[84:87], v[132:147]
    s_nop 0
    v_mfma_f32_32x32x16_bf16 v[132:147], v[80:83], v[88:91], v[132:147]
    v_mul_f32 v116, v116, v13
    v_mul_f32 v117, v117, v13
    v_mul_f32 v118, v118, v13
    v_mul_f32 v119, v119, v13
    v_mul_f32 v120, v120, v13
    v_mul_f32 v121, v121, v13
    v_mul_f32 v122, v122, v13
    v_mul_f32 v123, v123, v13
    v_mul_f32 v124, v124, v13
    v_mul_f32 v125, v125, v13
    v_mul_f32 v126, v126, v13
    v_mul_f32 v127, v127, v13
    v_mul_f32 v128, v128, v13
    v_mul_f32 v129, v129, v13
    v_mul_f32 v130, v130, v13
    v_mul_f32 v131, v131, v13
    v_max_f32 v16, v116, v117
    v_max3_f32 v16, v118, v119, v16
    v_max3_f32 v16, v120, v121, v16
    v_max3_f32 v16, v122, v123, v16
    v_max3_f32 v16, v124, v125, v16
    v_max3_f32 v16, v126, v127, v16
    v_max3_f32 v16, v128, v129, v16
    v_max3_f32 v16, v130, v131, v16
    v_mov_b32 v17, v16
    s_nop 1
    v_permlane32_swap_b32 v16, v17
    s_nop 1
    v_max3_f32 v16, v16, v17, v30
    v_sub_f32 v17, v30, v16
    v_exp_f32 v17, v17
    v_mov_b32 v30, v16
    v_mul_f32 v148, v148, v17
    v_mul_f32 v149, v149, v17
    v_mul_f32 v150, v150, v17
    v_mul_f32 v151, v151, v17
    v_mul_f32 v152, v152, v17
    v_mul_f32 v153, v153, v17
    v_mul_f32 v154, v154, v17
    v_mul_f32 v155, v155, v17
    v_mul_f32 v156, v156, v17
    v_mul_f32 v157, v157, v17
    v_mul_f32 v158, v158, v17
    v_mul_f32 v159, v159, v17
    v_mul_f32 v160, v160, v17
    v_mul_f32 v161, v161, v17
    v_mul_f32 v162, v162, v17
    v_mul_f32 v163, v163, v17
    v_sub_f32 v116, v116, v16
    v_sub_f32 v117, v117, v16
    v_sub_f32 v118, v118, v16
    v_sub_f32 v119, v119, v16
    v_sub_f32 v120, v120, v16
    v_sub_f32 v121, v121, v16
    v_sub_f32 v122, v122, v16
    v_sub_f32 v123, v123, v16
    v_sub_f32 v124, v124, v16
    v_sub_f32 v125, v125, v16
    v_sub_f32 v126, v126, v16
    v_sub_f32 v127, v127, v16
    v_sub_f32 v128, v128, v16
    v_sub_f32 v129, v129, v16
    v_sub_f32 v130, v130, v16
    v_sub_f32 v131, v131, v16
    v_exp_f32 v116, v116
    v_exp_f32 v117, v117
    v_exp_f32 v118, v118
    v_exp_f32 v119, v119
    v_exp_f32 v120, v120
    v_exp_f32 v121, v121
    v_exp_f32 v122, v122
    v_exp_f32 v123, v123
    v_exp_f32 v124, v124
    v_exp_f32 v125, v125
    v_exp_f32 v126, v126
    v_exp_f32 v127, v127
    v_exp_f32 v128, v128
    v_exp_f32 v129, v129
    v_exp_f32 v130, v130
    v_exp_f32 v131, v131
    v_cvt_pk_bf16_f32 v92, v116, v117
    v_cvt_pk_bf16_f32 v93, v118, v119
    v_cvt_pk_bf16_f32 v94, v120, v121
    v_cvt_pk_bf16_f32 v95, v122, v123
    v_cvt_pk_bf16_f32 v96, v124, v125
    v_cvt_pk_bf16_f32 v97, v126, v127
    v_cvt_pk_bf16_f32 v98, v128, v129
    v_cvt_pk_bf16_f32 v99, v130, v131
    v_mfma_f32_32x32x16_bf16 v[148:163], v[72:75], v[92:95], v[148:163]
    s_nop 0
    v_mfma_f32_32x32x16_bf16 v[148:163], v[80:83], v[96:99], v[148:163]
    s_waitcnt vmcnt(0) lgkmcnt(0)
    s_nop 15
    s_nop 5
    s_add_u32 s48, s48, 2304
    s_add_u32 s49, s49, 1
    s_cmp_lt_u32 s49, 32
    s_cbranch_scc1 L_g_pair
    v_rcp_f32 v20, v142
    s_nop 0
    v_pk_mul_f32 v[132:133], v[132:133], v[20:21] op_sel_hi:[1,0]
    v_pk_mul_f32 v[134:135], v[134:135], v[20:21] op_sel_hi:[1,0]
    v_pk_mul_f32 v[136:137], v[136:137], v[20:21] op_sel_hi:[1,0]
    v_pk_mul_f32 v[138:139], v[138:139], v[20:21] op_sel_hi:[1,0]
    v_pk_mul_f32 v[140:141], v[140:141], v[20:21] op_sel_hi:[1,0]
    v_cvt_pk_bf16_f32 v84, v132, v133
    v_cvt_pk_bf16_f32 v85, v134, v135
    v_cvt_pk_bf16_f32 v86, v136, v137
    v_cvt_pk_bf16_f32 v87, v138, v139
    v_cvt_pk_bf16_f32 v88, v140, v141
    buffer_store_dwordx4 v[84:87], v15, s[28:31], s37 offen offset:0
    buffer_store_dword v88, v28, s[28:31], s37 offen offset:16
    v_rcp_f32 v22, v158
    s_nop 0
    v_pk_mul_f32 v[148:149], v[148:149], v[22:23] op_sel_hi:[1,0]
    v_pk_mul_f32 v[150:151], v[150:151], v[22:23] op_sel_hi:[1,0]
    v_pk_mul_f32 v[152:153], v[152:153], v[22:23] op_sel_hi:[1,0]
    v_pk_mul_f32 v[154:155], v[154:155], v[22:23] op_sel_hi:[1,0]
    v_pk_mul_f32 v[156:157], v[156:157], v[22:23] op_sel_hi:[1,0]
    v_cvt_pk_bf16_f32 v92, v148, v149
    v_cvt_pk_bf16_f32 v93, v150, v151
    v_cvt_pk_bf16_f32 v94, v152, v153
    v_cvt_pk_bf16_f32 v95, v154, v155
    v_cvt_pk_bf16_f32 v96, v156, v157
    buffer_store_dwordx4 v[92:95], v15, s[28:31], s37 offen offset:1152
    buffer_store_dword v96, v28, s[28:31], s37 offen offset:1168
    s_waitcnt vmcnt(0) lgkmcnt(0)
    s_nop 15
    s_nop 5
    s_add_u32 s37, s37, 2304
    s_add_u32 s43, s43, 1
    s_cmp_lt_u32 s43, 2
    s_cbranch_scc1 L_g_half
    s_endpgm
.section .rodata,"a"
.p2align 6
.amdhsa_kernel standalone__qk_norm__prompt_kernel
  .amdhsa_next_free_vgpr 240
  .amdhsa_next_free_sgpr 64
  .amdhsa_accum_offset 240
  .amdhsa_group_segment_fixed_size 0
  .amdhsa_kernarg_size 56
  .amdhsa_user_sgpr_count 2
  .amdhsa_user_sgpr_kernarg_segment_ptr 1
  .amdhsa_system_sgpr_workgroup_id_x 1
.end_amdhsa_kernel
```
